```python
import torch

def _softmax(x, axis=-1):
    return torch.softmax(x, dim=axis)

def _gelu(x):
    return torch.nn.functional.gelu(x, approximate='tanh')

def _silu(x):
    return torch.nn.functional.silu(x)

def _sigmoid(x):
    return torch.sigmoid(x)

def _layernorm(x, axis=-1, eps=1e-05):
    m = x.mean(dim=axis, keepdim=True)
    v = x.var(dim=axis, keepdim=True, unbiased=False)
    return (x - m) / torch.sqrt(v + eps)

def _scatter_add(tgt, idx, src, axis=0):
    return tgt.clone().index_add_(axis, idx, src)

def _segment_sum(src, seg, n):
    out = torch.zeros((n,) + src.shape[1:], dtype=src.dtype)
    return out.index_add_(0, seg, src)

def _pad(x, pw):
    flat = tuple((v for pair in reversed(pw) for v in pair))
    return torch.nn.functional.pad(x, flat)
kernel_name = 'gated_mix__grouped_kv_mqa__memory_aug_recurrent_mem_tr__prompt'

def setup_inputs():

    _w = lambda a: (lambda t: t.to(torch.bfloat16) if t.is_floating_point() else t)(torch.as_tensor(a))

    def _A_setup():
        B, S, D, H = (1, 2048, 640, 32)
        Dh = D // H
        return {'x': _w((lambda *s: torch.randn(*s, dtype=torch.bfloat16) * 0.05)(B, S, D)), 'wq': _w((lambda *s: torch.randn(*s, dtype=torch.bfloat16) * 0.8)(D, H * Dh)), 'wk': _w((lambda *s: torch.randn(*s, dtype=torch.bfloat16) * 0.8)(D, Dh)), 'wv': _w((lambda *s: torch.randn(*s, dtype=torch.bfloat16) * 0.05)(D, Dh)), 'wo': _w((lambda *s: torch.randn(*s, dtype=torch.bfloat16) * 0.05)(H * Dh, D))}
    _A_in = _A_setup()

    def _B_setup():
        B, S, Dm = (1, 2048, 640)
        H, Dh = (32, 128)
        M, seg = (8, 32)
        seg = min(seg, S)
        S = S // seg * seg
        return {'x': _w((lambda *s: torch.randn(*s, dtype=torch.bfloat16) * 0.05)(B, S, Dm)), 'mem0': _w((lambda *s: torch.randn(*s, dtype=torch.bfloat16) * 0.4)(B, M, Dm)), 'Wq': _w((lambda *s: torch.randn(*s, dtype=torch.bfloat16) * 6.4)(Dm, H, Dh) * Dm ** (-0.5)), 'Wk': _w((lambda *s: torch.randn(*s, dtype=torch.bfloat16) * 6.4)(Dm, H, Dh) * Dm ** (-0.5)), 'Wv': _w((lambda *s: torch.randn(*s, dtype=torch.bfloat16) * 0.4)(Dm, H, Dh) * Dm ** (-0.5)), 'Wo': _w((lambda *s: torch.randn(*s, dtype=torch.bfloat16) * 0.4)(H, Dh, Dm) * (H * Dh) ** (-0.5)), 'seg_len': seg}
    _B_in = _B_setup()
    return {'A_x': _A_in['x'], 'A_wq': _A_in['wq'], 'A_wk': _A_in['wk'], 'A_wv': _A_in['wv'], 'A_wo': _A_in['wo'], 'B_x': _B_in['x'], 'B_mem0': _B_in['mem0'], 'B_Wq': _B_in['Wq'], 'B_Wk': _B_in['Wk'], 'B_Wv': _B_in['Wv'], 'B_Wo': _B_in['Wo'], 'B_seg_len': _B_in['seg_len'], 'gate_w': _w((lambda *s: torch.randn(*s, dtype=torch.bfloat16) * 0.05)(640) * 16.0)}

def reference(A_x, A_wq, A_wk, A_wv, A_wo, B_x, B_mem0, B_Wq, B_Wk, B_Wv, B_Wo, B_seg_len, gate_w):

    def _A_ref(x, wq, wk, wv, wo):
        B, S, D = x.shape
        H = 32
        Dh = D // H
        q = (lambda x, *d: x.permute(*d))((x @ wq).reshape(B, S, H, Dh), 0, 2, 1, 3)
        k = x @ wk
        v = x @ wv
        scores = torch.einsum('bhqd,bkd->bhqk', q, k) * Dh ** (-0.5)
        p = _softmax(scores, axis=-1)
        o = torch.einsum('bhqk,bkd->bhqd', p, v)
        return (lambda x, *d: x.permute(*d))(o, 0, 2, 1, 3).reshape(B, S, H * Dh) @ wo

    def _B_ref(x, mem0, Wq, Wk, Wv, Wo, seg_len):
        B, S, Dm = x.shape
        H, Dh = (Wq.shape[1], Wq.shape[2])
        M = mem0.shape[1]
        scale = Dh ** (-0.5)
        n_seg = S // seg_len
        L = M + seg_len
        idx = torch.arange(L)
        mask = (idx[:, None] < M) | (idx[:, None] >= idx[None, :])
        mem = mem0
        outs = []
        for s in range(n_seg):
            xs = x[:, s * seg_len:(s + 1) * seg_len, :].clone()
            h = torch.concatenate([mem, xs], axis=1)
            q = torch.einsum('btd,dhe->bhte', h, Wq)
            k = torch.einsum('btd,dhe->bhte', h, Wk)
            v = torch.einsum('btd,dhe->bhte', h, Wv)
            scores = torch.einsum('bhqe,bhke->bhqk', q, k) * scale
            scores = torch.where(mask[None, None], scores, -1000000000.0)
            p = _softmax(scores, axis=-1)
            o = torch.einsum('bhqk,bhke->bhqe', p, v)
            o = torch.einsum('bhte,hed->btd', o, Wo)
            mem = o[:, :M, :].clone()
            outs.append(o[:, M:, :])
        return torch.concatenate(outs, axis=1)
    x = A_x
    g = _sigmoid((x * gate_w).sum(-1, keepdims=True))
    a = _A_ref(x, A_wq, A_wk, A_wv, A_wo)
    b = _B_ref(x, B_mem0, B_Wq, B_Wk, B_Wv, B_Wo, B_seg_len)
    return g * a + (1 - g) * b
```

```asm
; @launch grid=(256,1,1) block=(256,1,1) lds=163840
.amdgcn_target "amdgcn-amd-amdhsa--gfx950"
.text
.globl gated_mix__grouped_kv_mqa__memory_aug_recurrent_mem_tr__prompt_kernel
.p2align 8
.type gated_mix__grouped_kv_mqa__memory_aug_recurrent_mem_tr__prompt_kernel,@function
gated_mix__grouped_kv_mqa__memory_aug_recurrent_mem_tr__prompt_kernel:
  s_cmp_ge_u32 s2, 256
  s_cbranch_scc1 END
  s_load_dwordx16 s[36:51], s[0:1], 0
  s_load_dwordx16 s[52:67], s[0:1], 64
  v_lshrrev_b32 v1, 6, v0
  s_nop 0
  v_readfirstlane_b32 s3, v1
  s_getreg_b32 s70, hwreg(HW_REG_XCC_ID)
  s_and_b32 s70, s70, 7
  s_mov_b32 s68, 200000
  s_waitcnt lgkmcnt(0)
  s_mov_b32 s4, s66
  s_mov_b32 s5, s67
  s_mov_b32 s6, 268435456
  s_mov_b32 s7, 0x20000
  s_mov_b32 s8, s36
  s_mov_b32 s9, s37
  s_mov_b32 s10, 2621440
  s_mov_b32 s11, 0x20000
  s_mov_b32 s28, s64
  s_mov_b32 s29, s65
  s_mov_b32 s30, 256
  s_mov_b32 s31, 0x20000
  s_cmp_lg_u32 s3, 0
  s_cbranch_scc1 P0_B
  v_lshlrev_b32 v1, 2, v0
  v_mov_b32 v2, 0
  s_lshl_b32 s72, s2, 7
  s_mov_b32 exec_hi, 0
  buffer_store_dword v2, v1, s[4:7], s72 offen sc1
  s_mov_b64 exec, 1
  v_mov_b32 v2, 1
  s_lshl_b32 s72, s70, 2
  v_mov_b32 v3, 0x10000
  buffer_atomic_add v2, off, s[28:31], s72 sc0
  s_waitcnt vmcnt(0)
  buffer_atomic_add v3, off, s[28:31], s72
  v_readfirstlane_b32 s71, v2
  s_and_b32 s71, s71, 0xffff
  s_mov_b64 exec, -1
  s_mov_b32 s69, s71
  s_cmp_lt_u32 s71, 32
  s_cselect_b32 s72, s70, 1
  s_cmp_eq_u32 s72, 0
  s_cbranch_scc1 P0_A
  v_mbcnt_lo_u32_b32 v1, -1, 0
  v_mbcnt_hi_u32_b32 v1, -1, v1
  v_lshlrev_b32 v1, 2, v1
L_1:
  buffer_load_dword v2, v1, s[28:31], 0 offen sc1
  s_waitcnt vmcnt(0)
  v_readlane_b32 s72, v2, 0
  v_readlane_b32 s73, v2, 1
  v_readlane_b32 s74, v2, 2
  v_readlane_b32 s75, v2, 3
  v_readlane_b32 s76, v2, 4
  v_readlane_b32 s77, v2, 5
  v_readlane_b32 s78, v2, 6
  v_readlane_b32 s79, v2, 7
  v_readlane_b32 s80, v2, 8
  s_mov_b32 s81, 0
  s_mov_b32 s69, s71
  s_lshr_b32 s72, s72, 16
  s_add_u32 s81, s81, s72
  s_cmp_gt_u32 s70, 0
  s_cselect_b32 s82, s72, 0
  s_add_u32 s69, s69, s82
  s_lshr_b32 s73, s73, 16
  s_add_u32 s81, s81, s73
  s_cmp_gt_u32 s70, 1
  s_cselect_b32 s82, s73, 0
  s_add_u32 s69, s69, s82
  s_lshr_b32 s74, s74, 16
  s_add_u32 s81, s81, s74
  s_cmp_gt_u32 s70, 2
  s_cselect_b32 s82, s74, 0
  s_add_u32 s69, s69, s82
  s_lshr_b32 s75, s75, 16
  s_add_u32 s81, s81, s75
  s_cmp_gt_u32 s70, 3
  s_cselect_b32 s82, s75, 0
  s_add_u32 s69, s69, s82
  s_lshr_b32 s76, s76, 16
  s_add_u32 s81, s81, s76
  s_cmp_gt_u32 s70, 4
  s_cselect_b32 s82, s76, 0
  s_add_u32 s69, s69, s82
  s_lshr_b32 s77, s77, 16
  s_add_u32 s81, s81, s77
  s_cmp_gt_u32 s70, 5
  s_cselect_b32 s82, s77, 0
  s_add_u32 s69, s69, s82
  s_lshr_b32 s78, s78, 16
  s_add_u32 s81, s81, s78
  s_cmp_gt_u32 s70, 6
  s_cselect_b32 s82, s78, 0
  s_add_u32 s69, s69, s82
  s_lshr_b32 s79, s79, 16
  s_add_u32 s81, s81, s79
  s_cmp_gt_u32 s70, 7
  s_cselect_b32 s82, s79, 0
  s_add_u32 s69, s69, s82
  s_cmp_ge_u32 s80, 0
  s_cselect_b32 s81, s81, 0
  s_cmp_ge_u32 s81, 256
  s_cbranch_scc1 D_2
  s_sub_u32 s68, s68, 1
  s_cbranch_scc0 L_1
  s_mov_b32 s68, 0
D_2:
P0_A:
  v_mov_b32 v1, 0
  v_mov_b32 v2, s69
  v_mov_b32 v3, s71
  ds_write_b64 v1, v[2:3]
  s_waitcnt lgkmcnt(0)
P0_B:
  s_barrier
  v_mov_b32 v1, 0
  ds_read_b64 v[2:3], v1
  s_waitcnt lgkmcnt(0)
  v_readfirstlane_b32 s69, v2
  v_readfirstlane_b32 s71, v3
  s_barrier
  s_cmp_lt_u32 s69, 32
  s_cbranch_scc1 CHAIN
  s_sub_u32 s72, s69, 32
  s_and_b32 s73, s72, 3
  s_lshr_b32 s72, s72, 2
  s_cmp_gt_u32 s72, 52
  s_cbranch_scc1 P1_END
  s_lshl_b32 s85, s72, 4
  s_lshl_b32 s86, s73, 2
  s_add_u32 s85, s85, s86
  s_lshl_b32 s86, s3, 6
  s_cmp_ge_u32 s72, 32
  s_cbranch_scc1 P1_C1
  s_mov_b32 s12, s52
  s_mov_b32 s13, s53
  s_mov_b32 s14, 5242880
  s_mov_b32 s15, 0x20000
  s_mov_b32 s16, s54
  s_mov_b32 s17, s55
  s_mov_b32 s18, 5242880
  s_mov_b32 s19, 0x20000
  s_mov_b32 s74, 0
  s_lshl_b32 s75, s72, 8
  s_add_u32 s75, s75, s86
  s_mov_b32 s76, s75
  s_mov_b32 s77, 8192
  s_lshl_b32 s78, s75, 6
  s_add_u32 s78, s78, 16777216
  s_add_u32 s79, s78, 2048
  s_mov_b32 s80, 524288
  s_branch P1_GO
P1_C1:
  s_cmp_ge_u32 s72, 48
  s_cbranch_scc1 P1_C2
  s_mov_b32 s12, s50
  s_mov_b32 s13, s51
  s_mov_b32 s14, 5242880
  s_mov_b32 s15, 0x20000
  s_mov_b32 s16, s50
  s_mov_b32 s17, s51
  s_mov_b32 s18, 5242880
  s_mov_b32 s19, 0x20000
  s_mov_b32 s74, 1
  s_sub_u32 s75, s72, 32
  s_lshl_b32 s75, s75, 9
  s_add_u32 s75, s75, s86
  s_add_u32 s76, s75, 256
  s_mov_b32 s77, 8192
  s_lshl_b32 s78, s75, 5
  s_add_u32 s78, s78, 50331648
  s_add_u32 s79, s78, 8192
  s_mov_b32 s80, 262144
  s_branch P1_GO
P1_C2:
  s_cmp_ge_u32 s72, 52
  s_cbranch_scc1 P1_C3
  s_mov_b32 s12, s38
  s_mov_b32 s13, s39
  s_mov_b32 s14, 819200
  s_mov_b32 s15, 0x20000
  s_mov_b32 s16, s38
  s_mov_b32 s17, s39
  s_mov_b32 s18, 819200
  s_mov_b32 s19, 0x20000
  s_mov_b32 s74, 2
  s_sub_u32 s78, s72, 48
  s_lshl_b32 s78, s78, 2
  s_add_u32 s78, s78, s3
  s_mul_i32 s75, s78, 80
  s_add_u32 s76, s75, 40
  s_mov_b32 s77, 1280
  s_lshl_b32 s78, s78, 12
  s_add_u32 s78, s78, 8388608
  s_add_u32 s79, s78, 2048
  s_mov_b32 s80, 65536
  s_branch P1_GO
P1_C3:
  s_mov_b32 s12, s40
  s_mov_b32 s13, s41
  s_mov_b32 s14, 25600
  s_mov_b32 s15, 0x20000
  s_mov_b32 s16, s42
  s_mov_b32 s17, s43
  s_mov_b32 s18, 25600
  s_mov_b32 s19, 0x20000
  s_mov_b32 s74, 3
  s_mov_b32 s75, 0
  s_mov_b32 s76, 0
  s_mov_b32 s77, 40
  s_mov_b32 s78, 65536
  s_mov_b32 s79, 67584
  s_mov_b32 s80, 4096
P1_GO:
  s_mul_i32 s86, s80, s73
  s_add_u32 s78, s78, s86
  s_add_u32 s79, s79, s86
  s_lshl_b32 s80, s80, 2
  s_mul_i32 s81, s73, 40960
  s_mul_i32 s84, s3, 40960
  s_lshl_b32 s87, s77, 4
  v_mbcnt_lo_u32_b32 v0, -1, 0
  v_mbcnt_hi_u32_b32 v0, -1, v0
  v_lshrrev_b32 v11, 2, v0
  v_mul_lo_u32 v1, v11, s77
  v_and_b32 v12, 3, v0
  v_lshl_add_u32 v1, v12, 4, v1
  v_lshrrev_b32 v10, 5, v0
  v_and_b32 v11, 3, v11
  v_lshl_add_u32 v11, v10, 3, v11
  v_lshlrev_b32 v2, 6, v11
  v_bfe_u32 v13, v0, 4, 1
  v_lshl_add_u32 v2, v13, 5, v2
  v_lshl_add_u32 v2, v12, 3, v2
  v_add_u32 v2, s84, v2
  v_lshrrev_b32 v11, 3, v0
  v_lshl_add_u32 v11, s3, 3, v11
  v_bfe_u32 v12, v11, 1, 3
  v_and_b32 v14, 7, v0
  v_xor_b32 v12, v12, v14
  v_mul_u32_u24 v3, 1280, v11
  v_lshl_add_u32 v3, v12, 4, v3
  v_and_b32 v11, 31, v0
  v_bfe_u32 v12, v0, 1, 3
  v_xor_b32 v12, v12, v10
  v_lshlrev_b32 v11, 7, v11
  v_lshl_add_u32 v4, v12, 4, v11
  v_xor_b32 v5, 32, v4
  v_xor_b32 v6, 64, v4
  v_xor_b32 v7, 0x60, v4
  v_and_b32 v11, 15, v0
  v_lshlrev_b32 v8, 4, v11
  v_lshl_add_u32 v8, v13, 10, v8
  v_lshl_add_u32 v8, v10, 8, v8
  v_lshlrev_b32 v9, 4, v0
  s_add_u32 m0, s84, 0
  s_nop 0
  buffer_load_dwordx4 v1, s[12:15], s75 offen lds
  s_add_u32 s75, s75, s87
  s_add_u32 m0, m0, 1024
  s_nop 0
  buffer_load_dwordx4 v1, s[12:15], s75 offen lds
  s_add_u32 s75, s75, s87
  s_add_u32 m0, m0, 1024
  s_nop 0
  buffer_load_dwordx4 v1, s[12:15], s75 offen lds
  s_add_u32 s75, s75, s87
  s_add_u32 m0, m0, 1024
  s_nop 0
  buffer_load_dwordx4 v1, s[12:15], s75 offen lds
  s_add_u32 s75, s75, s87
  s_add_u32 m0, s84, 4096
  s_nop 0
  buffer_load_dwordx4 v1, s[12:15], s75 offen lds
  s_add_u32 s75, s75, s87
  s_add_u32 m0, m0, 1024
  s_nop 0
  buffer_load_dwordx4 v1, s[12:15], s75 offen lds
  s_add_u32 s75, s75, s87
  s_add_u32 m0, m0, 1024
  s_nop 0
  buffer_load_dwordx4 v1, s[12:15], s75 offen lds
  s_add_u32 s75, s75, s87
  s_add_u32 m0, m0, 1024
  s_nop 0
  buffer_load_dwordx4 v1, s[12:15], s75 offen lds
  s_add_u32 s75, s75, s87
  s_add_u32 m0, s84, 8192
  s_nop 0
  buffer_load_dwordx4 v1, s[12:15], s75 offen lds
  s_add_u32 s75, s75, s87
  s_add_u32 m0, m0, 1024
  s_nop 0
  buffer_load_dwordx4 v1, s[12:15], s75 offen lds
  s_add_u32 s75, s75, s87
  s_add_u32 m0, m0, 1024
  s_nop 0
  buffer_load_dwordx4 v1, s[12:15], s75 offen lds
  s_add_u32 s75, s75, s87
  s_add_u32 m0, m0, 1024
  s_nop 0
  buffer_load_dwordx4 v1, s[12:15], s75 offen lds
  s_add_u32 s75, s75, s87
  s_add_u32 m0, s84, 12288
  s_nop 0
  buffer_load_dwordx4 v1, s[12:15], s75 offen lds
  s_add_u32 s75, s75, s87
  s_add_u32 m0, m0, 1024
  s_nop 0
  buffer_load_dwordx4 v1, s[12:15], s75 offen lds
  s_add_u32 s75, s75, s87
  s_add_u32 m0, m0, 1024
  s_nop 0
  buffer_load_dwordx4 v1, s[12:15], s75 offen lds
  s_add_u32 s75, s75, s87
  s_add_u32 m0, m0, 1024
  s_nop 0
  buffer_load_dwordx4 v1, s[12:15], s75 offen lds
  s_add_u32 s75, s75, s87
  s_add_u32 m0, s84, 16384
  s_nop 0
  buffer_load_dwordx4 v1, s[12:15], s75 offen lds
  s_add_u32 s75, s75, s87
  s_add_u32 m0, m0, 1024
  s_nop 0
  buffer_load_dwordx4 v1, s[12:15], s75 offen lds
  s_add_u32 s75, s75, s87
  s_add_u32 m0, m0, 1024
  s_nop 0
  buffer_load_dwordx4 v1, s[12:15], s75 offen lds
  s_add_u32 s75, s75, s87
  s_add_u32 m0, m0, 1024
  s_nop 0
  buffer_load_dwordx4 v1, s[12:15], s75 offen lds
  s_add_u32 s75, s75, s87
  s_add_u32 m0, s84, 20480
  s_nop 0
  buffer_load_dwordx4 v1, s[12:15], s75 offen lds
  s_add_u32 s75, s75, s87
  s_add_u32 m0, m0, 1024
  s_nop 0
  buffer_load_dwordx4 v1, s[12:15], s75 offen lds
  s_add_u32 s75, s75, s87
  s_add_u32 m0, m0, 1024
  s_nop 0
  buffer_load_dwordx4 v1, s[12:15], s75 offen lds
  s_add_u32 s75, s75, s87
  s_add_u32 m0, m0, 1024
  s_nop 0
  buffer_load_dwordx4 v1, s[12:15], s75 offen lds
  s_add_u32 s75, s75, s87
  s_add_u32 m0, s84, 24576
  s_nop 0
  buffer_load_dwordx4 v1, s[12:15], s75 offen lds
  s_add_u32 s75, s75, s87
  s_add_u32 m0, m0, 1024
  s_nop 0
  buffer_load_dwordx4 v1, s[12:15], s75 offen lds
  s_add_u32 s75, s75, s87
  s_add_u32 m0, m0, 1024
  s_nop 0
  buffer_load_dwordx4 v1, s[12:15], s75 offen lds
  s_add_u32 s75, s75, s87
  s_add_u32 m0, m0, 1024
  s_nop 0
  buffer_load_dwordx4 v1, s[12:15], s75 offen lds
  s_add_u32 s75, s75, s87
  s_add_u32 m0, s84, 28672
  s_nop 0
  buffer_load_dwordx4 v1, s[12:15], s75 offen lds
  s_add_u32 s75, s75, s87
  s_add_u32 m0, m0, 1024
  s_nop 0
  buffer_load_dwordx4 v1, s[12:15], s75 offen lds
  s_add_u32 s75, s75, s87
  s_add_u32 m0, m0, 1024
  s_nop 0
  buffer_load_dwordx4 v1, s[12:15], s75 offen lds
  s_add_u32 s75, s75, s87
  s_add_u32 m0, m0, 1024
  s_nop 0
  buffer_load_dwordx4 v1, s[12:15], s75 offen lds
  s_add_u32 s75, s75, s87
  s_add_u32 m0, s84, 32768
  s_nop 0
  buffer_load_dwordx4 v1, s[12:15], s75 offen lds
  s_add_u32 s75, s75, s87
  s_add_u32 m0, m0, 1024
  s_nop 0
  buffer_load_dwordx4 v1, s[12:15], s75 offen lds
  s_add_u32 s75, s75, s87
  s_add_u32 m0, m0, 1024
  s_nop 0
  buffer_load_dwordx4 v1, s[12:15], s75 offen lds
  s_add_u32 s75, s75, s87
  s_add_u32 m0, m0, 1024
  s_nop 0
  buffer_load_dwordx4 v1, s[12:15], s75 offen lds
  s_add_u32 s75, s75, s87
  s_add_u32 m0, s84, 36864
  s_nop 0
  buffer_load_dwordx4 v1, s[12:15], s75 offen lds
  s_add_u32 s75, s75, s87
  s_add_u32 m0, m0, 1024
  s_nop 0
  buffer_load_dwordx4 v1, s[12:15], s75 offen lds
  s_add_u32 s75, s75, s87
  s_add_u32 m0, m0, 1024
  s_nop 0
  buffer_load_dwordx4 v1, s[12:15], s75 offen lds
  s_add_u32 s75, s75, s87
  s_add_u32 m0, m0, 1024
  s_nop 0
  buffer_load_dwordx4 v1, s[12:15], s75 offen lds
  s_add_u32 s75, s75, s87
  s_waitcnt vmcnt(36)
  ds_read_b64_tr_b16 a[0:1], v2 offset:0
  ds_read_b64_tr_b16 a[2:3], v2 offset:256
  ds_read_b64_tr_b16 a[4:5], v2 offset:1024
  ds_read_b64_tr_b16 a[6:7], v2 offset:1280
  ds_read_b64_tr_b16 a[8:9], v2 offset:2048
  ds_read_b64_tr_b16 a[10:11], v2 offset:2304
  ds_read_b64_tr_b16 a[12:13], v2 offset:3072
  ds_read_b64_tr_b16 a[14:15], v2 offset:3328
  s_waitcnt lgkmcnt(0)
  s_add_u32 m0, s84, 0
  s_nop 0
  buffer_load_dwordx4 v1, s[16:19], s76 offen lds
  s_add_u32 s76, s76, s87
  s_add_u32 m0, m0, 1024
  s_nop 0
  buffer_load_dwordx4 v1, s[16:19], s76 offen lds
  s_add_u32 s76, s76, s87
  s_add_u32 m0, m0, 1024
  s_nop 0
  buffer_load_dwordx4 v1, s[16:19], s76 offen lds
  s_add_u32 s76, s76, s87
  s_add_u32 m0, m0, 1024
  s_nop 0
  buffer_load_dwordx4 v1, s[16:19], s76 offen lds
  s_add_u32 s76, s76, s87
  s_waitcnt vmcnt(36)
  ds_read_b64_tr_b16 a[16:17], v2 offset:4096
  ds_read_b64_tr_b16 a[18:19], v2 offset:4352
  ds_read_b64_tr_b16 a[20:21], v2 offset:5120
  ds_read_b64_tr_b16 a[22:23], v2 offset:5376
  ds_read_b64_tr_b16 a[24:25], v2 offset:6144
  ds_read_b64_tr_b16 a[26:27], v2 offset:6400
  ds_read_b64_tr_b16 a[28:29], v2 offset:7168
  ds_read_b64_tr_b16 a[30:31], v2 offset:7424
  s_waitcnt lgkmcnt(0)
  s_add_u32 m0, s84, 4096
  s_nop 0
  buffer_load_dwordx4 v1, s[16:19], s76 offen lds
  s_add_u32 s76, s76, s87
  s_add_u32 m0, m0, 1024
  s_nop 0
  buffer_load_dwordx4 v1, s[16:19], s76 offen lds
  s_add_u32 s76, s76, s87
  s_add_u32 m0, m0, 1024
  s_nop 0
  buffer_load_dwordx4 v1, s[16:19], s76 offen lds
  s_add_u32 s76, s76, s87
  s_add_u32 m0, m0, 1024
  s_nop 0
  buffer_load_dwordx4 v1, s[16:19], s76 offen lds
  s_add_u32 s76, s76, s87
  s_waitcnt vmcnt(36)
  ds_read_b64_tr_b16 a[32:33], v2 offset:8192
  ds_read_b64_tr_b16 a[34:35], v2 offset:8448
  ds_read_b64_tr_b16 a[36:37], v2 offset:9216
  ds_read_b64_tr_b16 a[38:39], v2 offset:9472
  ds_read_b64_tr_b16 a[40:41], v2 offset:10240
  ds_read_b64_tr_b16 a[42:43], v2 offset:10496
  ds_read_b64_tr_b16 a[44:45], v2 offset:11264
  ds_read_b64_tr_b16 a[46:47], v2 offset:11520
  s_waitcnt lgkmcnt(0)
  s_add_u32 m0, s84, 8192
  s_nop 0
  buffer_load_dwordx4 v1, s[16:19], s76 offen lds
  s_add_u32 s76, s76, s87
  s_add_u32 m0, m0, 1024
  s_nop 0
  buffer_load_dwordx4 v1, s[16:19], s76 offen lds
  s_add_u32 s76, s76, s87
  s_add_u32 m0, m0, 1024
  s_nop 0
  buffer_load_dwordx4 v1, s[16:19], s76 offen lds
  s_add_u32 s76, s76, s87
  s_add_u32 m0, m0, 1024
  s_nop 0
  buffer_load_dwordx4 v1, s[16:19], s76 offen lds
  s_add_u32 s76, s76, s87
  s_waitcnt vmcnt(36)
  ds_read_b64_tr_b16 a[48:49], v2 offset:12288
  ds_read_b64_tr_b16 a[50:51], v2 offset:12544
  ds_read_b64_tr_b16 a[52:53], v2 offset:13312
  ds_read_b64_tr_b16 a[54:55], v2 offset:13568
  ds_read_b64_tr_b16 a[56:57], v2 offset:14336
  ds_read_b64_tr_b16 a[58:59], v2 offset:14592
  ds_read_b64_tr_b16 a[60:61], v2 offset:15360
  ds_read_b64_tr_b16 a[62:63], v2 offset:15616
  s_waitcnt lgkmcnt(0)
  s_add_u32 m0, s84, 12288
  s_nop 0
  buffer_load_dwordx4 v1, s[16:19], s76 offen lds
  s_add_u32 s76, s76, s87
  s_add_u32 m0, m0, 1024
  s_nop 0
  buffer_load_dwordx4 v1, s[16:19], s76 offen lds
  s_add_u32 s76, s76, s87
  s_add_u32 m0, m0, 1024
  s_nop 0
  buffer_load_dwordx4 v1, s[16:19], s76 offen lds
  s_add_u32 s76, s76, s87
  s_add_u32 m0, m0, 1024
  s_nop 0
  buffer_load_dwordx4 v1, s[16:19], s76 offen lds
  s_add_u32 s76, s76, s87
  s_waitcnt vmcnt(36)
  ds_read_b64_tr_b16 a[64:65], v2 offset:16384
  ds_read_b64_tr_b16 a[66:67], v2 offset:16640
  ds_read_b64_tr_b16 a[68:69], v2 offset:17408
  ds_read_b64_tr_b16 a[70:71], v2 offset:17664
  ds_read_b64_tr_b16 a[72:73], v2 offset:18432
  ds_read_b64_tr_b16 a[74:75], v2 offset:18688
  ds_read_b64_tr_b16 a[76:77], v2 offset:19456
  ds_read_b64_tr_b16 a[78:79], v2 offset:19712
  s_waitcnt lgkmcnt(0)
  s_add_u32 m0, s84, 16384
  s_nop 0
  buffer_load_dwordx4 v1, s[16:19], s76 offen lds
  s_add_u32 s76, s76, s87
  s_add_u32 m0, m0, 1024
  s_nop 0
  buffer_load_dwordx4 v1, s[16:19], s76 offen lds
  s_add_u32 s76, s76, s87
  s_add_u32 m0, m0, 1024
  s_nop 0
  buffer_load_dwordx4 v1, s[16:19], s76 offen lds
  s_add_u32 s76, s76, s87
  s_add_u32 m0, m0, 1024
  s_nop 0
  buffer_load_dwordx4 v1, s[16:19], s76 offen lds
  s_add_u32 s76, s76, s87
  s_waitcnt vmcnt(36)
  ds_read_b64_tr_b16 a[80:81], v2 offset:20480
  ds_read_b64_tr_b16 a[82:83], v2 offset:20736
  ds_read_b64_tr_b16 a[84:85], v2 offset:21504
  ds_read_b64_tr_b16 a[86:87], v2 offset:21760
  ds_read_b64_tr_b16 a[88:89], v2 offset:22528
  ds_read_b64_tr_b16 a[90:91], v2 offset:22784
  ds_read_b64_tr_b16 a[92:93], v2 offset:23552
  ds_read_b64_tr_b16 a[94:95], v2 offset:23808
  s_waitcnt lgkmcnt(0)
  s_add_u32 m0, s84, 20480
  s_nop 0
  buffer_load_dwordx4 v1, s[16:19], s76 offen lds
  s_add_u32 s76, s76, s87
  s_add_u32 m0, m0, 1024
  s_nop 0
  buffer_load_dwordx4 v1, s[16:19], s76 offen lds
  s_add_u32 s76, s76, s87
  s_add_u32 m0, m0, 1024
  s_nop 0
  buffer_load_dwordx4 v1, s[16:19], s76 offen lds
  s_add_u32 s76, s76, s87
  s_add_u32 m0, m0, 1024
  s_nop 0
  buffer_load_dwordx4 v1, s[16:19], s76 offen lds
  s_add_u32 s76, s76, s87
  s_waitcnt vmcnt(36)
  ds_read_b64_tr_b16 a[96:97], v2 offset:24576
  ds_read_b64_tr_b16 a[98:99], v2 offset:24832
  ds_read_b64_tr_b16 a[100:101], v2 offset:25600
  ds_read_b64_tr_b16 a[102:103], v2 offset:25856
  ds_read_b64_tr_b16 a[104:105], v2 offset:26624
  ds_read_b64_tr_b16 a[106:107], v2 offset:26880
  ds_read_b64_tr_b16 a[108:109], v2 offset:27648
  ds_read_b64_tr_b16 a[110:111], v2 offset:27904
  s_waitcnt lgkmcnt(0)
  s_add_u32 m0, s84, 24576
  s_nop 0
  buffer_load_dwordx4 v1, s[16:19], s76 offen lds
  s_add_u32 s76, s76, s87
  s_add_u32 m0, m0, 1024
  s_nop 0
  buffer_load_dwordx4 v1, s[16:19], s76 offen lds
  s_add_u32 s76, s76, s87
  s_add_u32 m0, m0, 1024
  s_nop 0
  buffer_load_dwordx4 v1, s[16:19], s76 offen lds
  s_add_u32 s76, s76, s87
  s_add_u32 m0, m0, 1024
  s_nop 0
  buffer_load_dwordx4 v1, s[16:19], s76 offen lds
  s_add_u32 s76, s76, s87
  s_waitcnt vmcnt(36)
  ds_read_b64_tr_b16 a[112:113], v2 offset:28672
  ds_read_b64_tr_b16 a[114:115], v2 offset:28928
  ds_read_b64_tr_b16 a[116:117], v2 offset:29696
  ds_read_b64_tr_b16 a[118:119], v2 offset:29952
  ds_read_b64_tr_b16 a[120:121], v2 offset:30720
  ds_read_b64_tr_b16 a[122:123], v2 offset:30976
  ds_read_b64_tr_b16 a[124:125], v2 offset:31744
  ds_read_b64_tr_b16 a[126:127], v2 offset:32000
  s_waitcnt lgkmcnt(0)
  s_add_u32 m0, s84, 28672
  s_nop 0
  buffer_load_dwordx4 v1, s[16:19], s76 offen lds
  s_add_u32 s76, s76, s87
  s_add_u32 m0, m0, 1024
  s_nop 0
  buffer_load_dwordx4 v1, s[16:19], s76 offen lds
  s_add_u32 s76, s76, s87
  s_add_u32 m0, m0, 1024
  s_nop 0
  buffer_load_dwordx4 v1, s[16:19], s76 offen lds
  s_add_u32 s76, s76, s87
  s_add_u32 m0, m0, 1024
  s_nop 0
  buffer_load_dwordx4 v1, s[16:19], s76 offen lds
  s_add_u32 s76, s76, s87
  s_waitcnt vmcnt(36)
  ds_read_b64_tr_b16 a[128:129], v2 offset:32768
  ds_read_b64_tr_b16 a[130:131], v2 offset:33024
  ds_read_b64_tr_b16 a[132:133], v2 offset:33792
  ds_read_b64_tr_b16 a[134:135], v2 offset:34048
  ds_read_b64_tr_b16 a[136:137], v2 offset:34816
  ds_read_b64_tr_b16 a[138:139], v2 offset:35072
  ds_read_b64_tr_b16 a[140:141], v2 offset:35840
  ds_read_b64_tr_b16 a[142:143], v2 offset:36096
  s_waitcnt lgkmcnt(0)
  s_add_u32 m0, s84, 32768
  s_nop 0
  buffer_load_dwordx4 v1, s[16:19], s76 offen lds
  s_add_u32 s76, s76, s87
  s_add_u32 m0, m0, 1024
  s_nop 0
  buffer_load_dwordx4 v1, s[16:19], s76 offen lds
  s_add_u32 s76, s76, s87
  s_add_u32 m0, m0, 1024
  s_nop 0
  buffer_load_dwordx4 v1, s[16:19], s76 offen lds
  s_add_u32 s76, s76, s87
  s_add_u32 m0, m0, 1024
  s_nop 0
  buffer_load_dwordx4 v1, s[16:19], s76 offen lds
  s_add_u32 s76, s76, s87
  s_waitcnt vmcnt(36)
  ds_read_b64_tr_b16 a[144:145], v2 offset:36864
  ds_read_b64_tr_b16 a[146:147], v2 offset:37120
  ds_read_b64_tr_b16 a[148:149], v2 offset:37888
  ds_read_b64_tr_b16 a[150:151], v2 offset:38144
  ds_read_b64_tr_b16 a[152:153], v2 offset:38912
  ds_read_b64_tr_b16 a[154:155], v2 offset:39168
  ds_read_b64_tr_b16 a[156:157], v2 offset:39936
  ds_read_b64_tr_b16 a[158:159], v2 offset:40192
  s_waitcnt lgkmcnt(0)
  s_add_u32 m0, s84, 36864
  s_nop 0
  buffer_load_dwordx4 v1, s[16:19], s76 offen lds
  s_add_u32 s76, s76, s87
  s_add_u32 m0, m0, 1024
  s_nop 0
  buffer_load_dwordx4 v1, s[16:19], s76 offen lds
  s_add_u32 s76, s76, s87
  s_add_u32 m0, m0, 1024
  s_nop 0
  buffer_load_dwordx4 v1, s[16:19], s76 offen lds
  s_add_u32 s76, s76, s87
  s_add_u32 m0, m0, 1024
  s_nop 0
  buffer_load_dwordx4 v1, s[16:19], s76 offen lds
  s_add_u32 s76, s76, s87
  s_waitcnt vmcnt(36)
  ds_read_b64_tr_b16 a[160:161], v2 offset:0
  ds_read_b64_tr_b16 a[162:163], v2 offset:256
  ds_read_b64_tr_b16 a[164:165], v2 offset:1024
  ds_read_b64_tr_b16 a[166:167], v2 offset:1280
  ds_read_b64_tr_b16 a[168:169], v2 offset:2048
  ds_read_b64_tr_b16 a[170:171], v2 offset:2304
  ds_read_b64_tr_b16 a[172:173], v2 offset:3072
  ds_read_b64_tr_b16 a[174:175], v2 offset:3328
  s_waitcnt lgkmcnt(0)
  s_waitcnt vmcnt(32)
  ds_read_b64_tr_b16 a[176:177], v2 offset:4096
  ds_read_b64_tr_b16 a[178:179], v2 offset:4352
  ds_read_b64_tr_b16 a[180:181], v2 offset:5120
  ds_read_b64_tr_b16 a[182:183], v2 offset:5376
  ds_read_b64_tr_b16 a[184:185], v2 offset:6144
  ds_read_b64_tr_b16 a[186:187], v2 offset:6400
  ds_read_b64_tr_b16 a[188:189], v2 offset:7168
  ds_read_b64_tr_b16 a[190:191], v2 offset:7424
  s_waitcnt lgkmcnt(0)
  s_waitcnt vmcnt(28)
  ds_read_b64_tr_b16 a[192:193], v2 offset:8192
  ds_read_b64_tr_b16 a[194:195], v2 offset:8448
  ds_read_b64_tr_b16 a[196:197], v2 offset:9216
  ds_read_b64_tr_b16 a[198:199], v2 offset:9472
  ds_read_b64_tr_b16 a[200:201], v2 offset:10240
  ds_read_b64_tr_b16 a[202:203], v2 offset:10496
  ds_read_b64_tr_b16 a[204:205], v2 offset:11264
  ds_read_b64_tr_b16 a[206:207], v2 offset:11520
  s_waitcnt lgkmcnt(0)
  s_waitcnt vmcnt(24)
  ds_read_b64_tr_b16 a[208:209], v2 offset:12288
  ds_read_b64_tr_b16 a[210:211], v2 offset:12544
  ds_read_b64_tr_b16 a[212:213], v2 offset:13312
  ds_read_b64_tr_b16 a[214:215], v2 offset:13568
  ds_read_b64_tr_b16 a[216:217], v2 offset:14336
  ds_read_b64_tr_b16 a[218:219], v2 offset:14592
  ds_read_b64_tr_b16 a[220:221], v2 offset:15360
  ds_read_b64_tr_b16 a[222:223], v2 offset:15616
  s_waitcnt lgkmcnt(0)
  s_waitcnt vmcnt(20)
  ds_read_b64_tr_b16 a[224:225], v2 offset:16384
  ds_read_b64_tr_b16 a[226:227], v2 offset:16640
  ds_read_b64_tr_b16 a[228:229], v2 offset:17408
  ds_read_b64_tr_b16 a[230:231], v2 offset:17664
  ds_read_b64_tr_b16 a[232:233], v2 offset:18432
  ds_read_b64_tr_b16 a[234:235], v2 offset:18688
  ds_read_b64_tr_b16 a[236:237], v2 offset:19456
  ds_read_b64_tr_b16 a[238:239], v2 offset:19712
  s_waitcnt lgkmcnt(0)
  s_waitcnt vmcnt(16)
  ds_read_b64_tr_b16 a[240:241], v2 offset:20480
  ds_read_b64_tr_b16 a[242:243], v2 offset:20736
  ds_read_b64_tr_b16 a[244:245], v2 offset:21504
  ds_read_b64_tr_b16 a[246:247], v2 offset:21760
  ds_read_b64_tr_b16 a[248:249], v2 offset:22528
  ds_read_b64_tr_b16 a[250:251], v2 offset:22784
  ds_read_b64_tr_b16 a[252:253], v2 offset:23552
  ds_read_b64_tr_b16 a[254:255], v2 offset:23808
  s_waitcnt lgkmcnt(0)
  s_waitcnt vmcnt(12)
  ds_read_b64_tr_b16 v[192:193], v2 offset:24576
  ds_read_b64_tr_b16 v[194:195], v2 offset:24832
  ds_read_b64_tr_b16 v[196:197], v2 offset:25600
  ds_read_b64_tr_b16 v[198:199], v2 offset:25856
  ds_read_b64_tr_b16 v[200:201], v2 offset:26624
  ds_read_b64_tr_b16 v[202:203], v2 offset:26880
  ds_read_b64_tr_b16 v[204:205], v2 offset:27648
  ds_read_b64_tr_b16 v[206:207], v2 offset:27904
  s_waitcnt lgkmcnt(0)
  s_waitcnt vmcnt(8)
  ds_read_b64_tr_b16 v[208:209], v2 offset:28672
  ds_read_b64_tr_b16 v[210:211], v2 offset:28928
  ds_read_b64_tr_b16 v[212:213], v2 offset:29696
  ds_read_b64_tr_b16 v[214:215], v2 offset:29952
  ds_read_b64_tr_b16 v[216:217], v2 offset:30720
  ds_read_b64_tr_b16 v[218:219], v2 offset:30976
  ds_read_b64_tr_b16 v[220:221], v2 offset:31744
  ds_read_b64_tr_b16 v[222:223], v2 offset:32000
  s_waitcnt lgkmcnt(0)
  s_waitcnt vmcnt(4)
  ds_read_b64_tr_b16 v[224:225], v2 offset:32768
  ds_read_b64_tr_b16 v[226:227], v2 offset:33024
  ds_read_b64_tr_b16 v[228:229], v2 offset:33792
  ds_read_b64_tr_b16 v[230:231], v2 offset:34048
  ds_read_b64_tr_b16 v[232:233], v2 offset:34816
  ds_read_b64_tr_b16 v[234:235], v2 offset:35072
  ds_read_b64_tr_b16 v[236:237], v2 offset:35840
  ds_read_b64_tr_b16 v[238:239], v2 offset:36096
  s_waitcnt lgkmcnt(0)
  s_waitcnt vmcnt(0)
  ds_read_b64_tr_b16 v[240:241], v2 offset:36864
  ds_read_b64_tr_b16 v[242:243], v2 offset:37120
  ds_read_b64_tr_b16 v[244:245], v2 offset:37888
  ds_read_b64_tr_b16 v[246:247], v2 offset:38144
  ds_read_b64_tr_b16 v[248:249], v2 offset:38912
  ds_read_b64_tr_b16 v[250:251], v2 offset:39168
  ds_read_b64_tr_b16 v[252:253], v2 offset:39936
  ds_read_b64_tr_b16 v[254:255], v2 offset:40192
  s_waitcnt lgkmcnt(0)
  s_lshl_b32 s86, s74, 2
  s_add_u32 s86, s86, s3
  s_cmp_lg_u32 s86, 13
  s_cbranch_scc1 P1_NG
  s_mov_b32 s12, s60
  s_mov_b32 s13, s61
  s_mov_b32 s14, 1280
  s_mov_b32 s15, 0x20000
  v_lshlrev_b32 v11, 4, v10
  buffer_load_dwordx4 a[0:3], v11, s[12:15], 0 offen offset:0
  buffer_load_dwordx4 a[4:7], v11, s[12:15], 0 offen offset:32
  buffer_load_dwordx4 a[8:11], v11, s[12:15], 0 offen offset:64
  buffer_load_dwordx4 a[12:15], v11, s[12:15], 0 offen offset:96
  buffer_load_dwordx4 a[16:19], v11, s[12:15], 0 offen offset:128
  buffer_load_dwordx4 a[20:23], v11, s[12:15], 0 offen offset:160
  buffer_load_dwordx4 a[24:27], v11, s[12:15], 0 offen offset:192
  buffer_load_dwordx4 a[28:31], v11, s[12:15], 0 offen offset:224
  buffer_load_dwordx4 a[32:35], v11, s[12:15], 0 offen offset:256
  buffer_load_dwordx4 a[36:39], v11, s[12:15], 0 offen offset:288
  buffer_load_dwordx4 a[40:43], v11, s[12:15], 0 offen offset:320
  buffer_load_dwordx4 a[44:47], v11, s[12:15], 0 offen offset:352
  buffer_load_dwordx4 a[48:51], v11, s[12:15], 0 offen offset:384
  buffer_load_dwordx4 a[52:55], v11, s[12:15], 0 offen offset:416
  buffer_load_dwordx4 a[56:59], v11, s[12:15], 0 offen offset:448
  buffer_load_dwordx4 a[60:63], v11, s[12:15], 0 offen offset:480
  buffer_load_dwordx4 a[64:67], v11, s[12:15], 0 offen offset:512
  buffer_load_dwordx4 a[68:71], v11, s[12:15], 0 offen offset:544
  buffer_load_dwordx4 a[72:75], v11, s[12:15], 0 offen offset:576
  buffer_load_dwordx4 a[76:79], v11, s[12:15], 0 offen offset:608
  buffer_load_dwordx4 a[80:83], v11, s[12:15], 0 offen offset:640
  buffer_load_dwordx4 a[84:87], v11, s[12:15], 0 offen offset:672
  buffer_load_dwordx4 a[88:91], v11, s[12:15], 0 offen offset:704
  buffer_load_dwordx4 a[92:95], v11, s[12:15], 0 offen offset:736
  buffer_load_dwordx4 a[96:99], v11, s[12:15], 0 offen offset:768
  buffer_load_dwordx4 a[100:103], v11, s[12:15], 0 offen offset:800
  buffer_load_dwordx4 a[104:107], v11, s[12:15], 0 offen offset:832
  buffer_load_dwordx4 a[108:111], v11, s[12:15], 0 offen offset:864
  buffer_load_dwordx4 a[112:115], v11, s[12:15], 0 offen offset:896
  buffer_load_dwordx4 a[116:119], v11, s[12:15], 0 offen offset:928
  buffer_load_dwordx4 a[120:123], v11, s[12:15], 0 offen offset:960
  buffer_load_dwordx4 a[124:127], v11, s[12:15], 0 offen offset:992
  buffer_load_dwordx4 a[128:131], v11, s[12:15], 0 offen offset:1024
  buffer_load_dwordx4 a[132:135], v11, s[12:15], 0 offen offset:1056
  buffer_load_dwordx4 a[136:139], v11, s[12:15], 0 offen offset:1088
  buffer_load_dwordx4 a[140:143], v11, s[12:15], 0 offen offset:1120
  buffer_load_dwordx4 a[144:147], v11, s[12:15], 0 offen offset:1152
  buffer_load_dwordx4 a[148:151], v11, s[12:15], 0 offen offset:1184
  buffer_load_dwordx4 a[152:155], v11, s[12:15], 0 offen offset:1216
  buffer_load_dwordx4 a[156:159], v11, s[12:15], 0 offen offset:1248
  s_lshl_b32 s78, s73, 7
  s_add_u32 s78, s78, 32768
  s_mov_b32 s80, 512
P1_NG:
  s_barrier
  s_lshl_b32 s84, s3, 10
  s_mov_b32 s83, 40960
  s_mov_b32 s82, 0
  s_mov_b32 m0, s84
  s_nop 0
  buffer_load_dwordx4 v3, s[8:11], s81 offen offset:0 lds
  s_add_u32 m0, m0, 3968
  s_nop 0
  buffer_load_dwordx4 v3, s[8:11], s81 offen offset:128 lds
  s_add_u32 m0, m0, 3968
  s_nop 0
  buffer_load_dwordx4 v3, s[8:11], s81 offen offset:256 lds
  s_add_u32 m0, m0, 3968
  s_nop 0
  buffer_load_dwordx4 v3, s[8:11], s81 offen offset:384 lds
  s_add_u32 m0, m0, 3968
  s_nop 0
  buffer_load_dwordx4 v3, s[8:11], s81 offen offset:512 lds
  s_add_u32 m0, m0, 3968
  s_nop 0
  buffer_load_dwordx4 v3, s[8:11], s81 offen offset:640 lds
  s_add_u32 m0, m0, 3968
  s_nop 0
  buffer_load_dwordx4 v3, s[8:11], s81 offen offset:768 lds
  s_add_u32 m0, m0, 3968
  s_nop 0
  buffer_load_dwordx4 v3, s[8:11], s81 offen offset:896 lds
  s_add_u32 m0, m0, 3968
  s_nop 0
  buffer_load_dwordx4 v3, s[8:11], s81 offen offset:1024 lds
  s_add_u32 m0, m0, 3968
  s_nop 0
  buffer_load_dwordx4 v3, s[8:11], s81 offen offset:1152 lds
  s_add_u32 m0, m0, 3968
  s_waitcnt vmcnt(0) lgkmcnt(0)
P1_LOOP:
  s_waitcnt vmcnt(4)
  s_barrier
  s_add_u32 s84, s84, s83
  s_mov_b32 m0, s84
  s_add_u32 s81, s81, 163840
  s_cmp_lg_u32 s3, 0
  s_cbranch_scc1 P1_NF
  s_max_i32 s86, s82, 1
  s_sub_u32 s86, s86, 1
  v_mov_b32 v11, s86
  buffer_store_dword v11, off, s[4:7], s85 offset:0 sc1
P1_NF:
  s_add_u32 s86, s74, 1
  s_and_b32 s86, s86, 2
  s_cbranch_scc1 P1_TT
P1_TD:
  ds_read_b128 v[48:51], v4 offset:0
  ds_read_b128 v[52:55], v5 offset:0
  ds_read_b128 v[56:59], v6 offset:0
  ds_read_b128 v[60:63], v7 offset:0
  ds_read_b128 v[64:67], v4 offset:4096
  ds_read_b128 v[68:71], v5 offset:4096
  ds_read_b128 v[72:75], v6 offset:4096
  s_waitcnt lgkmcnt(6)
  v_mfma_f32_32x32x16_bf16 v[16:31], a[0:3], v[48:51], 0
  ds_read_b128 v[76:79], v7 offset:4096
  v_mfma_f32_32x32x16_bf16 v[32:47], v[48:51], a[160:163], 0
  buffer_load_dwordx4 v3, s[8:11], s81 offen offset:0 lds
  s_add_u32 m0, m0, 3968
  s_waitcnt lgkmcnt(6)
  v_mfma_f32_32x32x16_bf16 v[16:31], a[4:7], v[52:55], v[16:31]
  ds_read_b128 v[48:51], v4 offset:8192
  v_mfma_f32_32x32x16_bf16 v[32:47], v[52:55], a[164:167], v[32:47]
  buffer_load_dwordx4 v3, s[8:11], s81 offen offset:128 lds
  s_add_u32 m0, m0, 3968
  s_waitcnt lgkmcnt(6)
  v_mfma_f32_32x32x16_bf16 v[16:31], a[8:11], v[56:59], v[16:31]
  ds_read_b128 v[52:55], v5 offset:8192
  v_mfma_f32_32x32x16_bf16 v[32:47], v[56:59], a[168:171], v[32:47]
  buffer_load_dwordx4 v3, s[8:11], s81 offen offset:256 lds
  s_add_u32 m0, m0, 3968
  s_waitcnt lgkmcnt(6)
  v_mfma_f32_32x32x16_bf16 v[16:31], a[12:15], v[60:63], v[16:31]
  ds_read_b128 v[56:59], v6 offset:8192
  v_mfma_f32_32x32x16_bf16 v[32:47], v[60:63], a[172:175], v[32:47]
  buffer_load_dwordx4 v3, s[8:11], s81 offen offset:384 lds
  s_add_u32 m0, m0, 3968
  s_waitcnt lgkmcnt(6)
  v_mfma_f32_32x32x16_bf16 v[16:31], a[16:19], v[64:67], v[16:31]
  ds_read_b128 v[60:63], v7 offset:8192
  v_mfma_f32_32x32x16_bf16 v[32:47], v[64:67], a[176:179], v[32:47]
  buffer_load_dwordx4 v3, s[8:11], s81 offen offset:512 lds
  s_add_u32 m0, m0, 3968
  s_waitcnt lgkmcnt(6)
  v_mfma_f32_32x32x16_bf16 v[16:31], a[20:23], v[68:71], v[16:31]
  ds_read_b128 v[64:67], v4 offset:12288
  v_mfma_f32_32x32x16_bf16 v[32:47], v[68:71], a[180:183], v[32:47]
  buffer_load_dwordx4 v3, s[8:11], s81 offen offset:640 lds
  s_add_u32 m0, m0, 3968
  s_waitcnt lgkmcnt(6)
  v_mfma_f32_32x32x16_bf16 v[16:31], a[24:27], v[72:75], v[16:31]
  ds_read_b128 v[68:71], v5 offset:12288
  v_mfma_f32_32x32x16_bf16 v[32:47], v[72:75], a[184:187], v[32:47]
  buffer_load_dwordx4 v3, s[8:11], s81 offen offset:768 lds
  s_add_u32 m0, m0, 3968
  s_waitcnt lgkmcnt(6)
  v_mfma_f32_32x32x16_bf16 v[16:31], a[28:31], v[76:79], v[16:31]
  ds_read_b128 v[72:75], v6 offset:12288
  v_mfma_f32_32x32x16_bf16 v[32:47], v[76:79], a[188:191], v[32:47]
  buffer_load_dwordx4 v3, s[8:11], s81 offen offset:896 lds
  s_add_u32 m0, m0, 3968
  s_waitcnt lgkmcnt(6)
  v_mfma_f32_32x32x16_bf16 v[16:31], a[32:35], v[48:51], v[16:31]
  ds_read_b128 v[76:79], v7 offset:12288
  v_mfma_f32_32x32x16_bf16 v[32:47], v[48:51], a[192:195], v[32:47]
  buffer_load_dwordx4 v3, s[8:11], s81 offen offset:1024 lds
  s_add_u32 m0, m0, 3968
  s_waitcnt lgkmcnt(6)
  v_mfma_f32_32x32x16_bf16 v[16:31], a[36:39], v[52:55], v[16:31]
  ds_read_b128 v[48:51], v4 offset:16384
  v_mfma_f32_32x32x16_bf16 v[32:47], v[52:55], a[196:199], v[32:47]
  buffer_load_dwordx4 v3, s[8:11], s81 offen offset:1152 lds
  s_add_u32 m0, m0, 3968
  s_waitcnt lgkmcnt(6)
  v_mfma_f32_32x32x16_bf16 v[16:31], a[40:43], v[56:59], v[16:31]
  ds_read_b128 v[52:55], v5 offset:16384
  v_mfma_f32_32x32x16_bf16 v[32:47], v[56:59], a[200:203], v[32:47]
  s_waitcnt lgkmcnt(6)
  v_mfma_f32_32x32x16_bf16 v[16:31], a[44:47], v[60:63], v[16:31]
  ds_read_b128 v[56:59], v6 offset:16384
  v_mfma_f32_32x32x16_bf16 v[32:47], v[60:63], a[204:207], v[32:47]
  s_waitcnt lgkmcnt(6)
  v_mfma_f32_32x32x16_bf16 v[16:31], a[48:51], v[64:67], v[16:31]
  ds_read_b128 v[60:63], v7 offset:16384
  v_mfma_f32_32x32x16_bf16 v[32:47], v[64:67], a[208:211], v[32:47]
  s_waitcnt lgkmcnt(6)
  v_mfma_f32_32x32x16_bf16 v[16:31], a[52:55], v[68:71], v[16:31]
  ds_read_b128 v[64:67], v4 offset:20480
  v_mfma_f32_32x32x16_bf16 v[32:47], v[68:71], a[212:215], v[32:47]
  s_waitcnt lgkmcnt(6)
  v_mfma_f32_32x32x16_bf16 v[16:31], a[56:59], v[72:75], v[16:31]
  ds_read_b128 v[68:71], v5 offset:20480
  v_mfma_f32_32x32x16_bf16 v[32:47], v[72:75], a[216:219], v[32:47]
  s_waitcnt lgkmcnt(6)
  v_mfma_f32_32x32x16_bf16 v[16:31], a[60:63], v[76:79], v[16:31]
  ds_read_b128 v[72:75], v6 offset:20480
  v_mfma_f32_32x32x16_bf16 v[32:47], v[76:79], a[220:223], v[32:47]
  s_waitcnt lgkmcnt(6)
  v_mfma_f32_32x32x16_bf16 v[16:31], a[64:67], v[48:51], v[16:31]
  ds_read_b128 v[76:79], v7 offset:20480
  v_mfma_f32_32x32x16_bf16 v[32:47], v[48:51], a[224:227], v[32:47]
  s_waitcnt lgkmcnt(6)
  v_mfma_f32_32x32x16_bf16 v[16:31], a[68:71], v[52:55], v[16:31]
  ds_read_b128 v[48:51], v4 offset:24576
  v_mfma_f32_32x32x16_bf16 v[32:47], v[52:55], a[228:231], v[32:47]
  s_waitcnt lgkmcnt(6)
  v_mfma_f32_32x32x16_bf16 v[16:31], a[72:75], v[56:59], v[16:31]
  ds_read_b128 v[52:55], v5 offset:24576
  v_mfma_f32_32x32x16_bf16 v[32:47], v[56:59], a[232:235], v[32:47]
  s_waitcnt lgkmcnt(6)
  v_mfma_f32_32x32x16_bf16 v[16:31], a[76:79], v[60:63], v[16:31]
  ds_read_b128 v[56:59], v6 offset:24576
  v_mfma_f32_32x32x16_bf16 v[32:47], v[60:63], a[236:239], v[32:47]
  s_waitcnt lgkmcnt(6)
  v_mfma_f32_32x32x16_bf16 v[16:31], a[80:83], v[64:67], v[16:31]
  ds_read_b128 v[60:63], v7 offset:24576
  v_mfma_f32_32x32x16_bf16 v[32:47], v[64:67], a[240:243], v[32:47]
  s_waitcnt lgkmcnt(6)
  v_mfma_f32_32x32x16_bf16 v[16:31], a[84:87], v[68:71], v[16:31]
  ds_read_b128 v[64:67], v4 offset:28672
  v_mfma_f32_32x32x16_bf16 v[32:47], v[68:71], a[244:247], v[32:47]
  s_waitcnt lgkmcnt(6)
  v_mfma_f32_32x32x16_bf16 v[16:31], a[88:91], v[72:75], v[16:31]
  ds_read_b128 v[68:71], v5 offset:28672
  v_mfma_f32_32x32x16_bf16 v[32:47], v[72:75], a[248:251], v[32:47]
  s_waitcnt lgkmcnt(6)
  v_mfma_f32_32x32x16_bf16 v[16:31], a[92:95], v[76:79], v[16:31]
  ds_read_b128 v[72:75], v6 offset:28672
  v_mfma_f32_32x32x16_bf16 v[32:47], v[76:79], a[252:255], v[32:47]
  s_waitcnt lgkmcnt(6)
  v_mfma_f32_32x32x16_bf16 v[16:31], a[96:99], v[48:51], v[16:31]
  ds_read_b128 v[76:79], v7 offset:28672
  v_mfma_f32_32x32x16_bf16 v[32:47], v[48:51], v[192:195], v[32:47]
  s_waitcnt lgkmcnt(6)
  v_mfma_f32_32x32x16_bf16 v[16:31], a[100:103], v[52:55], v[16:31]
  ds_read_b128 v[48:51], v4 offset:32768
  v_mfma_f32_32x32x16_bf16 v[32:47], v[52:55], v[196:199], v[32:47]
  s_waitcnt lgkmcnt(6)
  v_mfma_f32_32x32x16_bf16 v[16:31], a[104:107], v[56:59], v[16:31]
  ds_read_b128 v[52:55], v5 offset:32768
  v_mfma_f32_32x32x16_bf16 v[32:47], v[56:59], v[200:203], v[32:47]
  s_waitcnt lgkmcnt(6)
  v_mfma_f32_32x32x16_bf16 v[16:31], a[108:111], v[60:63], v[16:31]
  ds_read_b128 v[56:59], v6 offset:32768
  v_mfma_f32_32x32x16_bf16 v[32:47], v[60:63], v[204:207], v[32:47]
  s_waitcnt lgkmcnt(6)
  v_mfma_f32_32x32x16_bf16 v[16:31], a[112:115], v[64:67], v[16:31]
  ds_read_b128 v[60:63], v7 offset:32768
  v_mfma_f32_32x32x16_bf16 v[32:47], v[64:67], v[208:211], v[32:47]
  s_waitcnt lgkmcnt(6)
  v_mfma_f32_32x32x16_bf16 v[16:31], a[116:119], v[68:71], v[16:31]
  ds_read_b128 v[64:67], v4 offset:36864
  v_mfma_f32_32x32x16_bf16 v[32:47], v[68:71], v[212:215], v[32:47]
  s_waitcnt lgkmcnt(6)
  v_mfma_f32_32x32x16_bf16 v[16:31], a[120:123], v[72:75], v[16:31]
  ds_read_b128 v[68:71], v5 offset:36864
  v_mfma_f32_32x32x16_bf16 v[32:47], v[72:75], v[216:219], v[32:47]
  s_waitcnt lgkmcnt(6)
  v_mfma_f32_32x32x16_bf16 v[16:31], a[124:127], v[76:79], v[16:31]
  ds_read_b128 v[72:75], v6 offset:36864
  v_mfma_f32_32x32x16_bf16 v[32:47], v[76:79], v[220:223], v[32:47]
  s_waitcnt lgkmcnt(6)
  v_mfma_f32_32x32x16_bf16 v[16:31], a[128:131], v[48:51], v[16:31]
  ds_read_b128 v[76:79], v7 offset:36864
  v_mfma_f32_32x32x16_bf16 v[32:47], v[48:51], v[224:227], v[32:47]
  s_waitcnt lgkmcnt(6)
  v_mfma_f32_32x32x16_bf16 v[16:31], a[132:135], v[52:55], v[16:31]
  v_mfma_f32_32x32x16_bf16 v[32:47], v[52:55], v[228:231], v[32:47]
  s_waitcnt lgkmcnt(5)
  v_mfma_f32_32x32x16_bf16 v[16:31], a[136:139], v[56:59], v[16:31]
  v_mfma_f32_32x32x16_bf16 v[32:47], v[56:59], v[232:235], v[32:47]
  s_waitcnt lgkmcnt(4)
  v_mfma_f32_32x32x16_bf16 v[16:31], a[140:143], v[60:63], v[16:31]
  v_mfma_f32_32x32x16_bf16 v[32:47], v[60:63], v[236:239], v[32:47]
  s_waitcnt lgkmcnt(3)
  v_mfma_f32_32x32x16_bf16 v[16:31], a[144:147], v[64:67], v[16:31]
  v_mfma_f32_32x32x16_bf16 v[32:47], v[64:67], v[240:243], v[32:47]
  v_add_u32 v4, s83, v4
  s_waitcnt lgkmcnt(2)
  v_mfma_f32_32x32x16_bf16 v[16:31], a[148:151], v[68:71], v[16:31]
  v_mfma_f32_32x32x16_bf16 v[32:47], v[68:71], v[244:247], v[32:47]
  v_add_u32 v5, s83, v5
  s_waitcnt lgkmcnt(1)
  v_mfma_f32_32x32x16_bf16 v[16:31], a[152:155], v[72:75], v[16:31]
  v_mfma_f32_32x32x16_bf16 v[32:47], v[72:75], v[248:251], v[32:47]
  v_add_u32 v6, s83, v6
  s_waitcnt lgkmcnt(0)
  v_mfma_f32_32x32x16_bf16 v[16:31], a[156:159], v[76:79], v[16:31]
  v_mfma_f32_32x32x16_bf16 v[32:47], v[76:79], v[252:255], v[32:47]
  v_add_u32 v7, s83, v7
  s_branch P1_EP
P1_TT:
  ds_read_b128 v[48:51], v4 offset:0
  ds_read_b128 v[52:55], v5 offset:0
  ds_read_b128 v[56:59], v6 offset:0
  ds_read_b128 v[60:63], v7 offset:0
  ds_read_b128 v[64:67], v4 offset:4096
  ds_read_b128 v[68:71], v5 offset:4096
  ds_read_b128 v[72:75], v6 offset:4096
  s_waitcnt lgkmcnt(6)
  v_mfma_f32_32x32x16_bf16 v[16:31], a[0:3], v[48:51], 0
  ds_read_b128 v[76:79], v7 offset:4096
  v_mfma_f32_32x32x16_bf16 v[32:47], a[160:163], v[48:51], 0
  buffer_load_dwordx4 v3, s[8:11], s81 offen offset:0 lds
  s_add_u32 m0, m0, 3968
  s_waitcnt lgkmcnt(6)
  v_mfma_f32_32x32x16_bf16 v[16:31], a[4:7], v[52:55], v[16:31]
  ds_read_b128 v[48:51], v4 offset:8192
  v_mfma_f32_32x32x16_bf16 v[32:47], a[164:167], v[52:55], v[32:47]
  buffer_load_dwordx4 v3, s[8:11], s81 offen offset:128 lds
  s_add_u32 m0, m0, 3968
  s_waitcnt lgkmcnt(6)
  v_mfma_f32_32x32x16_bf16 v[16:31], a[8:11], v[56:59], v[16:31]
  ds_read_b128 v[52:55], v5 offset:8192
  v_mfma_f32_32x32x16_bf16 v[32:47], a[168:171], v[56:59], v[32:47]
  buffer_load_dwordx4 v3, s[8:11], s81 offen offset:256 lds
  s_add_u32 m0, m0, 3968
  s_waitcnt lgkmcnt(6)
  v_mfma_f32_32x32x16_bf16 v[16:31], a[12:15], v[60:63], v[16:31]
  ds_read_b128 v[56:59], v6 offset:8192
  v_mfma_f32_32x32x16_bf16 v[32:47], a[172:175], v[60:63], v[32:47]
  buffer_load_dwordx4 v3, s[8:11], s81 offen offset:384 lds
  s_add_u32 m0, m0, 3968
  s_waitcnt lgkmcnt(6)
  v_mfma_f32_32x32x16_bf16 v[16:31], a[16:19], v[64:67], v[16:31]
  ds_read_b128 v[60:63], v7 offset:8192
  v_mfma_f32_32x32x16_bf16 v[32:47], a[176:179], v[64:67], v[32:47]
  buffer_load_dwordx4 v3, s[8:11], s81 offen offset:512 lds
  s_add_u32 m0, m0, 3968
  s_waitcnt lgkmcnt(6)
  v_mfma_f32_32x32x16_bf16 v[16:31], a[20:23], v[68:71], v[16:31]
  ds_read_b128 v[64:67], v4 offset:12288
  v_mfma_f32_32x32x16_bf16 v[32:47], a[180:183], v[68:71], v[32:47]
  buffer_load_dwordx4 v3, s[8:11], s81 offen offset:640 lds
  s_add_u32 m0, m0, 3968
  s_waitcnt lgkmcnt(6)
  v_mfma_f32_32x32x16_bf16 v[16:31], a[24:27], v[72:75], v[16:31]
  ds_read_b128 v[68:71], v5 offset:12288
  v_mfma_f32_32x32x16_bf16 v[32:47], a[184:187], v[72:75], v[32:47]
  buffer_load_dwordx4 v3, s[8:11], s81 offen offset:768 lds
  s_add_u32 m0, m0, 3968
  s_waitcnt lgkmcnt(6)
  v_mfma_f32_32x32x16_bf16 v[16:31], a[28:31], v[76:79], v[16:31]
  ds_read_b128 v[72:75], v6 offset:12288
  v_mfma_f32_32x32x16_bf16 v[32:47], a[188:191], v[76:79], v[32:47]
  buffer_load_dwordx4 v3, s[8:11], s81 offen offset:896 lds
  s_add_u32 m0, m0, 3968
  s_waitcnt lgkmcnt(6)
  v_mfma_f32_32x32x16_bf16 v[16:31], a[32:35], v[48:51], v[16:31]
  ds_read_b128 v[76:79], v7 offset:12288
  v_mfma_f32_32x32x16_bf16 v[32:47], a[192:195], v[48:51], v[32:47]
  buffer_load_dwordx4 v3, s[8:11], s81 offen offset:1024 lds
  s_add_u32 m0, m0, 3968
  s_waitcnt lgkmcnt(6)
  v_mfma_f32_32x32x16_bf16 v[16:31], a[36:39], v[52:55], v[16:31]
  ds_read_b128 v[48:51], v4 offset:16384
  v_mfma_f32_32x32x16_bf16 v[32:47], a[196:199], v[52:55], v[32:47]
  buffer_load_dwordx4 v3, s[8:11], s81 offen offset:1152 lds
  s_add_u32 m0, m0, 3968
  s_waitcnt lgkmcnt(6)
  v_mfma_f32_32x32x16_bf16 v[16:31], a[40:43], v[56:59], v[16:31]
  ds_read_b128 v[52:55], v5 offset:16384
  v_mfma_f32_32x32x16_bf16 v[32:47], a[200:203], v[56:59], v[32:47]
  s_waitcnt lgkmcnt(6)
  v_mfma_f32_32x32x16_bf16 v[16:31], a[44:47], v[60:63], v[16:31]
  ds_read_b128 v[56:59], v6 offset:16384
  v_mfma_f32_32x32x16_bf16 v[32:47], a[204:207], v[60:63], v[32:47]
  s_waitcnt lgkmcnt(6)
  v_mfma_f32_32x32x16_bf16 v[16:31], a[48:51], v[64:67], v[16:31]
  ds_read_b128 v[60:63], v7 offset:16384
  v_mfma_f32_32x32x16_bf16 v[32:47], a[208:211], v[64:67], v[32:47]
  s_waitcnt lgkmcnt(6)
  v_mfma_f32_32x32x16_bf16 v[16:31], a[52:55], v[68:71], v[16:31]
  ds_read_b128 v[64:67], v4 offset:20480
  v_mfma_f32_32x32x16_bf16 v[32:47], a[212:215], v[68:71], v[32:47]
  s_waitcnt lgkmcnt(6)
  v_mfma_f32_32x32x16_bf16 v[16:31], a[56:59], v[72:75], v[16:31]
  ds_read_b128 v[68:71], v5 offset:20480
  v_mfma_f32_32x32x16_bf16 v[32:47], a[216:219], v[72:75], v[32:47]
  s_waitcnt lgkmcnt(6)
  v_mfma_f32_32x32x16_bf16 v[16:31], a[60:63], v[76:79], v[16:31]
  ds_read_b128 v[72:75], v6 offset:20480
  v_mfma_f32_32x32x16_bf16 v[32:47], a[220:223], v[76:79], v[32:47]
  s_waitcnt lgkmcnt(6)
  v_mfma_f32_32x32x16_bf16 v[16:31], a[64:67], v[48:51], v[16:31]
  ds_read_b128 v[76:79], v7 offset:20480
  v_mfma_f32_32x32x16_bf16 v[32:47], a[224:227], v[48:51], v[32:47]
  s_waitcnt lgkmcnt(6)
  v_mfma_f32_32x32x16_bf16 v[16:31], a[68:71], v[52:55], v[16:31]
  ds_read_b128 v[48:51], v4 offset:24576
  v_mfma_f32_32x32x16_bf16 v[32:47], a[228:231], v[52:55], v[32:47]
  s_waitcnt lgkmcnt(6)
  v_mfma_f32_32x32x16_bf16 v[16:31], a[72:75], v[56:59], v[16:31]
  ds_read_b128 v[52:55], v5 offset:24576
  v_mfma_f32_32x32x16_bf16 v[32:47], a[232:235], v[56:59], v[32:47]
  s_waitcnt lgkmcnt(6)
  v_mfma_f32_32x32x16_bf16 v[16:31], a[76:79], v[60:63], v[16:31]
  ds_read_b128 v[56:59], v6 offset:24576
  v_mfma_f32_32x32x16_bf16 v[32:47], a[236:239], v[60:63], v[32:47]
  s_waitcnt lgkmcnt(6)
  v_mfma_f32_32x32x16_bf16 v[16:31], a[80:83], v[64:67], v[16:31]
  ds_read_b128 v[60:63], v7 offset:24576
  v_mfma_f32_32x32x16_bf16 v[32:47], a[240:243], v[64:67], v[32:47]
  s_waitcnt lgkmcnt(6)
  v_mfma_f32_32x32x16_bf16 v[16:31], a[84:87], v[68:71], v[16:31]
  ds_read_b128 v[64:67], v4 offset:28672
  v_mfma_f32_32x32x16_bf16 v[32:47], a[244:247], v[68:71], v[32:47]
  s_waitcnt lgkmcnt(6)
  v_mfma_f32_32x32x16_bf16 v[16:31], a[88:91], v[72:75], v[16:31]
  ds_read_b128 v[68:71], v5 offset:28672
  v_mfma_f32_32x32x16_bf16 v[32:47], a[248:251], v[72:75], v[32:47]
  s_waitcnt lgkmcnt(6)
  v_mfma_f32_32x32x16_bf16 v[16:31], a[92:95], v[76:79], v[16:31]
  ds_read_b128 v[72:75], v6 offset:28672
  v_mfma_f32_32x32x16_bf16 v[32:47], a[252:255], v[76:79], v[32:47]
  s_waitcnt lgkmcnt(6)
  v_mfma_f32_32x32x16_bf16 v[16:31], a[96:99], v[48:51], v[16:31]
  ds_read_b128 v[76:79], v7 offset:28672
  v_mfma_f32_32x32x16_bf16 v[32:47], v[192:195], v[48:51], v[32:47]
  s_waitcnt lgkmcnt(6)
  v_mfma_f32_32x32x16_bf16 v[16:31], a[100:103], v[52:55], v[16:31]
  ds_read_b128 v[48:51], v4 offset:32768
  v_mfma_f32_32x32x16_bf16 v[32:47], v[196:199], v[52:55], v[32:47]
  s_waitcnt lgkmcnt(6)
  v_mfma_f32_32x32x16_bf16 v[16:31], a[104:107], v[56:59], v[16:31]
  ds_read_b128 v[52:55], v5 offset:32768
  v_mfma_f32_32x32x16_bf16 v[32:47], v[200:203], v[56:59], v[32:47]
  s_waitcnt lgkmcnt(6)
  v_mfma_f32_32x32x16_bf16 v[16:31], a[108:111], v[60:63], v[16:31]
  ds_read_b128 v[56:59], v6 offset:32768
  v_mfma_f32_32x32x16_bf16 v[32:47], v[204:207], v[60:63], v[32:47]
  s_waitcnt lgkmcnt(6)
  v_mfma_f32_32x32x16_bf16 v[16:31], a[112:115], v[64:67], v[16:31]
  ds_read_b128 v[60:63], v7 offset:32768
  v_mfma_f32_32x32x16_bf16 v[32:47], v[208:211], v[64:67], v[32:47]
  s_waitcnt lgkmcnt(6)
  v_mfma_f32_32x32x16_bf16 v[16:31], a[116:119], v[68:71], v[16:31]
  ds_read_b128 v[64:67], v4 offset:36864
  v_mfma_f32_32x32x16_bf16 v[32:47], v[212:215], v[68:71], v[32:47]
  s_waitcnt lgkmcnt(6)
  v_mfma_f32_32x32x16_bf16 v[16:31], a[120:123], v[72:75], v[16:31]
  ds_read_b128 v[68:71], v5 offset:36864
  v_mfma_f32_32x32x16_bf16 v[32:47], v[216:219], v[72:75], v[32:47]
  s_waitcnt lgkmcnt(6)
  v_mfma_f32_32x32x16_bf16 v[16:31], a[124:127], v[76:79], v[16:31]
  ds_read_b128 v[72:75], v6 offset:36864
  v_mfma_f32_32x32x16_bf16 v[32:47], v[220:223], v[76:79], v[32:47]
  s_waitcnt lgkmcnt(6)
  v_mfma_f32_32x32x16_bf16 v[16:31], a[128:131], v[48:51], v[16:31]
  ds_read_b128 v[76:79], v7 offset:36864
  v_mfma_f32_32x32x16_bf16 v[32:47], v[224:227], v[48:51], v[32:47]
  s_waitcnt lgkmcnt(6)
  v_mfma_f32_32x32x16_bf16 v[16:31], a[132:135], v[52:55], v[16:31]
  v_mfma_f32_32x32x16_bf16 v[32:47], v[228:231], v[52:55], v[32:47]
  s_waitcnt lgkmcnt(5)
  v_mfma_f32_32x32x16_bf16 v[16:31], a[136:139], v[56:59], v[16:31]
  v_mfma_f32_32x32x16_bf16 v[32:47], v[232:235], v[56:59], v[32:47]
  s_waitcnt lgkmcnt(4)
  v_mfma_f32_32x32x16_bf16 v[16:31], a[140:143], v[60:63], v[16:31]
  v_mfma_f32_32x32x16_bf16 v[32:47], v[236:239], v[60:63], v[32:47]
  s_waitcnt lgkmcnt(3)
  v_mfma_f32_32x32x16_bf16 v[16:31], a[144:147], v[64:67], v[16:31]
  v_mfma_f32_32x32x16_bf16 v[32:47], v[240:243], v[64:67], v[32:47]
  v_add_u32 v4, s83, v4
  s_waitcnt lgkmcnt(2)
  v_mfma_f32_32x32x16_bf16 v[16:31], a[148:151], v[68:71], v[16:31]
  v_mfma_f32_32x32x16_bf16 v[32:47], v[244:247], v[68:71], v[32:47]
  v_add_u32 v5, s83, v5
  s_waitcnt lgkmcnt(1)
  v_mfma_f32_32x32x16_bf16 v[16:31], a[152:155], v[72:75], v[16:31]
  v_mfma_f32_32x32x16_bf16 v[32:47], v[248:251], v[72:75], v[32:47]
  v_add_u32 v6, s83, v6
  s_waitcnt lgkmcnt(0)
  v_mfma_f32_32x32x16_bf16 v[16:31], a[156:159], v[76:79], v[16:31]
  v_mfma_f32_32x32x16_bf16 v[32:47], v[252:255], v[76:79], v[32:47]
  v_add_u32 v7, s83, v7
P1_EP:
  s_sub_u32 s83, 0, s83
  s_cmp_ge_u32 s74, 2
  s_cbranch_scc1 P1_EA
  s_nop 6
  v_cvt_pk_bf16_f32 v80, v16, v17
  v_cvt_pk_bf16_f32 v81, v18, v19
  v_cvt_pk_bf16_f32 v82, v24, v25
  v_cvt_pk_bf16_f32 v83, v26, v27
  buffer_store_dwordx4 v[80:83], v8, s[4:7], s78 offen offset:0 sc1
  v_cvt_pk_bf16_f32 v84, v20, v21
  v_cvt_pk_bf16_f32 v85, v22, v23
  v_cvt_pk_bf16_f32 v86, v28, v29
  v_cvt_pk_bf16_f32 v87, v30, v31
  buffer_store_dwordx4 v[84:87], v8, s[4:7], s78 offen offset:512 sc1
  v_cvt_pk_bf16_f32 v88, v32, v33
  v_cvt_pk_bf16_f32 v89, v34, v35
  v_cvt_pk_bf16_f32 v90, v40, v41
  v_cvt_pk_bf16_f32 v91, v42, v43
  buffer_store_dwordx4 v[88:91], v8, s[4:7], s79 offen offset:0 sc1
  v_cvt_pk_bf16_f32 v92, v36, v37
  v_cvt_pk_bf16_f32 v93, v38, v39
  v_cvt_pk_bf16_f32 v94, v44, v45
  v_cvt_pk_bf16_f32 v95, v46, v47
  buffer_store_dwordx4 v[92:95], v8, s[4:7], s79 offen offset:512 sc1
  s_branch P1_NX
P1_EA:
  s_nop 7
  s_nop 3
  s_cmp_eq_u32 s74, 3
  s_cbranch_scc1 P1_EK
  s_mov_b32 s86, 0x3ea52b5c
  v_mul_f32 v16, s86, v16
  v_mul_f32 v17, s86, v17
  v_mul_f32 v18, s86, v18
  v_mul_f32 v19, s86, v19
  v_mul_f32 v20, s86, v20
  v_mul_f32 v21, s86, v21
  v_mul_f32 v22, s86, v22
  v_mul_f32 v23, s86, v23
  v_mul_f32 v24, s86, v24
  v_mul_f32 v25, s86, v25
  v_mul_f32 v26, s86, v26
  v_mul_f32 v27, s86, v27
  v_mul_f32 v28, s86, v28
  v_mul_f32 v29, s86, v29
  v_mul_f32 v30, s86, v30
  v_mul_f32 v31, s86, v31
  v_mul_f32 v32, s86, v32
  v_mul_f32 v33, s86, v33
  v_mul_f32 v34, s86, v34
  v_mul_f32 v35, s86, v35
  v_mul_f32 v36, s86, v36
  v_mul_f32 v37, s86, v37
  v_mul_f32 v38, s86, v38
  v_mul_f32 v39, s86, v39
  v_mul_f32 v40, s86, v40
  v_mul_f32 v41, s86, v41
  v_mul_f32 v42, s86, v42
  v_mul_f32 v43, s86, v43
  v_mul_f32 v44, s86, v44
  v_mul_f32 v45, s86, v45
  v_mul_f32 v46, s86, v46
  v_mul_f32 v47, s86, v47
P1_EA2:
  v_cvt_pk_bf16_f32 v80, v16, v17
  v_cvt_pk_bf16_f32 v81, v18, v19
  v_cvt_pk_bf16_f32 v82, v20, v21
  v_cvt_pk_bf16_f32 v83, v22, v23
  buffer_store_dwordx4 v[80:83], v9, s[4:7], s78 offen offset:0 sc1
  v_cvt_pk_bf16_f32 v84, v24, v25
  v_cvt_pk_bf16_f32 v85, v26, v27
  v_cvt_pk_bf16_f32 v86, v28, v29
  v_cvt_pk_bf16_f32 v87, v30, v31
  buffer_store_dwordx4 v[84:87], v9, s[4:7], s78 offen offset:1024 sc1
  v_cvt_pk_bf16_f32 v88, v32, v33
  v_cvt_pk_bf16_f32 v89, v34, v35
  v_cvt_pk_bf16_f32 v90, v36, v37
  v_cvt_pk_bf16_f32 v91, v38, v39
  buffer_store_dwordx4 v[88:91], v9, s[4:7], s79 offen offset:0 sc1
  v_cvt_pk_bf16_f32 v92, v40, v41
  v_cvt_pk_bf16_f32 v93, v42, v43
  v_cvt_pk_bf16_f32 v94, v44, v45
  v_cvt_pk_bf16_f32 v95, v46, v47
  buffer_store_dwordx4 v[92:95], v9, s[4:7], s79 offen offset:1024 sc1
  s_branch P1_NX
P1_EK:
  s_cmp_lg_u32 s3, 0
  s_cbranch_scc1 P1_EG
  v_mov_b32 v28, 0
  v_mov_b32 v29, 0
  v_mov_b32 v30, 0
  v_mov_b32 v31, 0
  s_mov_b32 exec_lo, 0
  v_mov_b32 v24, 0
  v_mov_b32 v25, 0
  v_mov_b32 v26, 0
  v_mov_b32 v27, 0
  s_mov_b32 exec_lo, 0xfff00000
  s_mov_b32 exec_hi, 0xfff00000
  v_mov_b32 v32, 1.0
  v_mov_b32 v33, 1.0
  v_mov_b32 v34, 1.0
  v_mov_b32 v35, 1.0
  v_mov_b32 v36, 1.0
  v_mov_b32 v37, 1.0
  v_mov_b32 v38, 1.0
  v_mov_b32 v39, 1.0
  v_mov_b32 v40, 1.0
  v_mov_b32 v41, 1.0
  v_mov_b32 v42, 1.0
  v_mov_b32 v43, 1.0
  v_mov_b32 v44, 1.0
  v_mov_b32 v45, 1.0
  v_mov_b32 v46, 1.0
  v_mov_b32 v47, 1.0
  s_mov_b64 exec, -1
  s_branch P1_EA2
P1_EG:
  s_cmp_lg_u32 s3, 1
  s_cbranch_scc1 P1_EZ
  v_mul_f32 v16, 0xbfb8aa3b, v16
  v_exp_f32 v16, v16
  s_nop 0
  v_add_f32 v16, 1.0, v16
  v_rcp_f32 v16, v16
  v_and_b32 v11, 31, v0
  v_lshlrev_b32 v11, 2, v11
  buffer_store_dword v16, v11, s[4:7], s78 offen sc1
P1_EZ:
  s_waitcnt vmcnt(0)
P1_NX:
  s_add_u32 s78, s78, s80
  s_add_u32 s79, s79, s80
  s_add_u32 s82, s82, 1
  s_cmp_lt_u32 s82, 16
  s_cbranch_scc1 P1_LOOP
  s_waitcnt vmcnt(0) lgkmcnt(0)
  s_barrier
  v_mov_b32 v11, 16
  buffer_store_dword v11, off, s[4:7], s85 offset:0 sc1
P1_END:
  s_sub_u32 s72, s69, 32
  s_and_b32 s73, s72, 31
  s_lshr_b32 s72, s72, 5
  s_mul_i32 s74, s72, 20
  s_add_u32 s74, s74, s73
  s_cmp_lt_u32 s73, 20
  s_cbranch_scc1 P3
  s_mul_i32 s74, s72, 12
  s_add_u32 s74, s74, s73
  s_sub_u32 s74, s74, 20
  s_cmp_lt_u32 s74, 32
  s_cbranch_scc1 T1
  s_add_u32 s74, s74, 108
P3:
  s_lshl_b32 s74, s74, 2
  s_add_u32 s74, s74, s3
  s_mul_i32 s74, s74, 3
  s_cmp_ge_u32 s74, 2048
  s_cbranch_scc1 P3_END
  v_mbcnt_lo_u32_b32 v1, -1, 0
  v_mbcnt_hi_u32_b32 v1, -1, v1
  v_lshlrev_b32 v0, 4, v1
  v_min_u32 v2, 19, v1
  v_lshlrev_b32 v2, 2, v2
  s_movk_i32 s75, 768
L_3:
  buffer_load_dword v3, v2, s[4:7], s75 offen sc1
  s_waitcnt vmcnt(0)
  v_cmp_ne_u32 vcc, 16, v3
  s_cbranch_vccz D_4
  s_sub_u32 s68, s68, 1
  s_cbranch_scc0 L_3
  s_mov_b32 s68, 0
D_4:
  s_add_u32 s76, s74, 0
  s_min_u32 s76, s76, 2047
  s_lshl_b32 s75, s76, 11
  s_add_u32 s75, s75, 8388608
  buffer_load_dwordx4 v[184:187], v0, s[4:7], s75 offen offset:0 sc1
  buffer_load_dwordx4 v[188:191], v0, s[4:7], s75 offen offset:1024 sc1
  s_add_u32 s77, s74, 1
  s_min_u32 s77, s77, 2047
  s_lshl_b32 s75, s77, 11
  s_add_u32 s75, s75, 8388608
  buffer_load_dwordx4 v[192:195], v0, s[4:7], s75 offen offset:0 sc1
  buffer_load_dwordx4 v[196:199], v0, s[4:7], s75 offen offset:1024 sc1
  s_add_u32 s78, s74, 2
  s_min_u32 s78, s78, 2047
  s_lshl_b32 s75, s78, 11
  s_add_u32 s75, s75, 8388608
  buffer_load_dwordx4 v[200:203], v0, s[4:7], s75 offen offset:0 sc1
  buffer_load_dwordx4 v[204:207], v0, s[4:7], s75 offen offset:1024 sc1
  s_mov_b32 s79, 65536
  s_mov_b32 s80, 69632
  buffer_load_dwordx4 v[208:211], v0, s[4:7], s79 offen offset:0 sc1
  buffer_load_dwordx4 v[212:215], v0, s[4:7], s79 offen offset:1024 sc1
  buffer_load_dwordx4 v[224:227], v0, s[4:7], s79 offen offset:2048 sc1
  buffer_load_dwordx4 v[228:231], v0, s[4:7], s79 offen offset:3072 sc1
  buffer_load_dwordx4 v[216:219], v0, s[4:7], s80 offen offset:0 sc1
  buffer_load_dwordx4 v[220:223], v0, s[4:7], s80 offen offset:1024 sc1
  v_mov_b64 v[64:65], 0
  v_mov_b64 v[66:67], 0
  v_mov_b64 v[68:69], 0
  v_mov_b64 v[70:71], 0
  v_mov_b64 v[72:73], 0
  v_mov_b64 v[74:75], 0
  v_mov_b64 v[76:77], 0
  v_mov_b64 v[78:79], 0
  v_mov_b64 v[80:81], 0
  v_mov_b64 v[82:83], 0
  v_mov_b64 v[84:85], 0
  v_mov_b64 v[86:87], 0
  v_mov_b64 v[88:89], 0
  v_mov_b64 v[90:91], 0
  v_mov_b64 v[92:93], 0
  v_mov_b64 v[94:95], 0
  v_mov_b64 v[96:97], 0
  v_mov_b64 v[98:99], 0
  v_mov_b64 v[100:101], 0
  v_mov_b64 v[102:103], 0
  v_mov_b64 v[104:105], 0
  v_mov_b64 v[106:107], 0
  v_mov_b64 v[108:109], 0
  v_mov_b64 v[110:111], 0
  v_mov_b64 v[112:113], 0
  v_mov_b64 v[114:115], 0
  v_mov_b64 v[116:117], 0
  v_mov_b64 v[118:119], 0
  v_mov_b64 v[120:121], 0
  v_mov_b64 v[122:123], 0
  v_mov_b64 v[124:125], 0
  v_mov_b64 v[126:127], 0
  v_mov_b64 v[128:129], 0
  v_mov_b64 v[130:131], 0
  v_mov_b64 v[132:133], 0
  v_mov_b64 v[134:135], 0
  v_mov_b64 v[136:137], 0
  v_mov_b64 v[138:139], 0
  v_mov_b64 v[140:141], 0
  v_mov_b64 v[142:143], 0
  v_mov_b64 v[144:145], 0
  v_mov_b64 v[146:147], 0
  v_mov_b64 v[148:149], 0
  v_mov_b64 v[150:151], 0
  v_mov_b64 v[152:153], 0
  v_mov_b64 v[154:155], 0
  v_mov_b64 v[156:157], 0
  v_mov_b64 v[158:159], 0
  v_mov_b64 v[160:161], 0
  v_mov_b64 v[162:163], 0
  v_mov_b64 v[164:165], 0
  v_mov_b64 v[166:167], 0
  v_mov_b64 v[168:169], 0
  v_mov_b64 v[170:171], 0
  v_mov_b64 v[172:173], 0
  v_mov_b64 v[174:175], 0
  v_mov_b64 v[176:177], 0
  v_mov_b64 v[178:179], 0
  v_mov_b64 v[180:181], 0
  v_mov_b64 v[182:183], 0
  v_mov_b64 v[232:233], 0
  v_mov_b64 v[234:235], 0
  v_mov_b64 v[236:237], 0
  v_mov_b64 v[238:239], 0
  s_mov_b32 s79, 73728
  s_mov_b32 s81, 0xff800000
  s_mov_b32 s82, 0xff800000
  s_mov_b32 s83, 0
  s_waitcnt vmcnt(4)
  v_mfma_f32_32x32x16_bf16 v[16:31], v[208:211], v[184:187], v[112:127]
  v_mfma_f32_32x32x16_bf16 v[16:31], v[212:215], v[188:191], v[16:31]
  s_nop 7
  s_nop 3
P3_L:
  v_mfma_f32_32x32x16_bf16 v[32:47], v[208:211], v[192:195], v[128:143]
  v_max3_f32 v4, v16, v17, v18
  v_max3_f32 v5, v19, v20, v21
  v_max3_f32 v4, v4, v22, v23
  v_max3_f32 v5, v5, v24, v25
  v_max3_f32 v4, v4, v26, v27
  v_max3_f32 v5, v5, v28, v29
  v_max3_f32 v4, v4, v30, v31
  v_mfma_f32_32x32x16_bf16 v[32:47], v[212:215], v[196:199], v[32:47]
  v_max_f32 v4, v4, v5
  v_cmp_lt_f32 vcc, s81, v4
  s_cbranch_vccnz P3_S00
P3_R00:
  v_exp_f32 v16, v16
  v_exp_f32 v17, v17
  v_exp_f32 v18, v18
  v_mfma_f32_32x32x16_bf16 v[96:111], v[232:235], v[176:179], v[96:111]
  v_exp_f32 v19, v19
  v_exp_f32 v20, v20
  v_exp_f32 v21, v21
  v_cvt_pk_bf16_f32 v160, v16, v17
  v_cvt_pk_bf16_f32 v161, v18, v19
  v_mfma_f32_32x32x16_bf16 v[96:111], v[236:239], v[180:183], v[96:111]
  v_exp_f32 v22, v22
  v_exp_f32 v23, v23
  v_exp_f32 v24, v24
  v_exp_f32 v25, v25
  buffer_load_dwordx4 v[232:235], v0, s[4:7], s80 offen offset:2048 sc1
  buffer_load_dwordx4 v[236:239], v0, s[4:7], s80 offen offset:3072 sc1
  s_add_u32 s80, s80, 4096
  v_exp_f32 v26, v26
  v_exp_f32 v27, v27
  v_exp_f32 v28, v28
  v_exp_f32 v29, v29
  v_exp_f32 v30, v30
  v_exp_f32 v31, v31
  v_cvt_pk_bf16_f32 v162, v20, v21
  v_cvt_pk_bf16_f32 v163, v22, v23
  v_cvt_pk_bf16_f32 v164, v24, v25
  v_cvt_pk_bf16_f32 v165, v26, v27
  v_cvt_pk_bf16_f32 v166, v28, v29
  v_cvt_pk_bf16_f32 v167, v30, v31
  s_waitcnt vmcnt(4)
  v_mfma_f32_32x32x16_bf16 v[48:63], v[208:211], v[200:203], v[144:159]
  v_max3_f32 v4, v32, v33, v34
  v_max3_f32 v5, v35, v36, v37
  v_max3_f32 v4, v4, v38, v39
  v_max3_f32 v5, v5, v40, v41
  v_max3_f32 v4, v4, v42, v43
  v_max3_f32 v5, v5, v44, v45
  v_max3_f32 v4, v4, v46, v47
  v_mfma_f32_32x32x16_bf16 v[48:63], v[212:215], v[204:207], v[48:63]
  v_max_f32 v4, v4, v5
  v_cmp_lt_f32 vcc, s81, v4
  s_cbranch_vccnz P3_S01
P3_R01:
  v_exp_f32 v32, v32
  v_exp_f32 v33, v33
  v_exp_f32 v34, v34
  v_mfma_f32_32x32x16_bf16 v[64:79], v[224:227], v[160:163], v[64:79]
  v_exp_f32 v35, v35
  v_exp_f32 v36, v36
  v_exp_f32 v37, v37
  buffer_load_dwordx4 v[208:211], v0, s[4:7], s79 offen offset:0 sc1
  buffer_load_dwordx4 v[212:215], v0, s[4:7], s79 offen offset:1024 sc1
  s_add_u32 s79, s79, 4096
  v_cvt_pk_bf16_f32 v168, v32, v33
  v_cvt_pk_bf16_f32 v169, v34, v35
  v_mfma_f32_32x32x16_bf16 v[64:79], v[228:231], v[164:167], v[64:79]
  v_exp_f32 v38, v38
  v_exp_f32 v39, v39
  v_exp_f32 v40, v40
  v_exp_f32 v41, v41
  v_exp_f32 v42, v42
  v_exp_f32 v43, v43
  v_exp_f32 v44, v44
  v_exp_f32 v45, v45
  v_exp_f32 v46, v46
  v_exp_f32 v47, v47
  v_cvt_pk_bf16_f32 v170, v36, v37
  v_cvt_pk_bf16_f32 v171, v38, v39
  v_cvt_pk_bf16_f32 v172, v40, v41
  v_cvt_pk_bf16_f32 v173, v42, v43
  v_cvt_pk_bf16_f32 v174, v44, v45
  v_cvt_pk_bf16_f32 v175, v46, v47
  s_waitcnt vmcnt(4)
  v_mfma_f32_32x32x16_bf16 v[16:31], v[216:219], v[184:187], v[112:127]
  v_max3_f32 v4, v48, v49, v50
  v_max3_f32 v5, v51, v52, v53
  v_max3_f32 v4, v4, v54, v55
  v_max3_f32 v5, v5, v56, v57
  v_max3_f32 v4, v4, v58, v59
  v_max3_f32 v5, v5, v60, v61
  v_max3_f32 v4, v4, v62, v63
  v_mfma_f32_32x32x16_bf16 v[16:31], v[220:223], v[188:191], v[16:31]
  v_max_f32 v4, v4, v5
  v_cmp_lt_f32 vcc, s81, v4
  s_cbranch_vccnz P3_S02
P3_R02:
  v_exp_f32 v48, v48
  v_exp_f32 v49, v49
  v_exp_f32 v50, v50
  v_mfma_f32_32x32x16_bf16 v[80:95], v[224:227], v[168:171], v[80:95]
  v_exp_f32 v51, v51
  v_exp_f32 v52, v52
  v_exp_f32 v53, v53
  v_cvt_pk_bf16_f32 v176, v48, v49
  v_cvt_pk_bf16_f32 v177, v50, v51
  v_mfma_f32_32x32x16_bf16 v[80:95], v[228:231], v[172:175], v[80:95]
  v_exp_f32 v54, v54
  v_exp_f32 v55, v55
  v_exp_f32 v56, v56
  v_exp_f32 v57, v57
  v_exp_f32 v58, v58
  v_exp_f32 v59, v59
  v_exp_f32 v60, v60
  v_exp_f32 v61, v61
  v_exp_f32 v62, v62
  v_exp_f32 v63, v63
  v_cvt_pk_bf16_f32 v178, v52, v53
  v_cvt_pk_bf16_f32 v179, v54, v55
  v_cvt_pk_bf16_f32 v180, v56, v57
  v_cvt_pk_bf16_f32 v181, v58, v59
  v_cvt_pk_bf16_f32 v182, v60, v61
  v_cvt_pk_bf16_f32 v183, v62, v63
  s_mov_b32 s81, 0x41000000
  s_mov_b32 s82, 0
  v_mfma_f32_32x32x16_bf16 v[32:47], v[216:219], v[192:195], v[128:143]
  v_max3_f32 v4, v16, v17, v18
  v_max3_f32 v5, v19, v20, v21
  v_max3_f32 v4, v4, v22, v23
  v_max3_f32 v5, v5, v24, v25
  v_max3_f32 v4, v4, v26, v27
  v_max3_f32 v5, v5, v28, v29
  v_max3_f32 v4, v4, v30, v31
  v_mfma_f32_32x32x16_bf16 v[32:47], v[220:223], v[196:199], v[32:47]
  v_max_f32 v4, v4, v5
  v_cmp_lt_f32 vcc, s81, v4
  s_cbranch_vccnz P3_S10
P3_R10:
  v_exp_f32 v16, v16
  v_exp_f32 v17, v17
  v_exp_f32 v18, v18
  v_mfma_f32_32x32x16_bf16 v[96:111], v[224:227], v[176:179], v[96:111]
  v_exp_f32 v19, v19
  v_exp_f32 v20, v20
  v_exp_f32 v21, v21
  v_cvt_pk_bf16_f32 v160, v16, v17
  v_cvt_pk_bf16_f32 v161, v18, v19
  v_mfma_f32_32x32x16_bf16 v[96:111], v[228:231], v[180:183], v[96:111]
  v_exp_f32 v22, v22
  v_exp_f32 v23, v23
  v_exp_f32 v24, v24
  v_exp_f32 v25, v25
  buffer_load_dwordx4 v[224:227], v0, s[4:7], s80 offen offset:2048 sc1
  buffer_load_dwordx4 v[228:231], v0, s[4:7], s80 offen offset:3072 sc1
  s_add_u32 s80, s80, 4096
  v_exp_f32 v26, v26
  v_exp_f32 v27, v27
  v_exp_f32 v28, v28
  v_exp_f32 v29, v29
  v_exp_f32 v30, v30
  v_exp_f32 v31, v31
  v_cvt_pk_bf16_f32 v162, v20, v21
  v_cvt_pk_bf16_f32 v163, v22, v23
  v_cvt_pk_bf16_f32 v164, v24, v25
  v_cvt_pk_bf16_f32 v165, v26, v27
  v_cvt_pk_bf16_f32 v166, v28, v29
  v_cvt_pk_bf16_f32 v167, v30, v31
  s_waitcnt vmcnt(4)
  v_mfma_f32_32x32x16_bf16 v[48:63], v[216:219], v[200:203], v[144:159]
  v_max3_f32 v4, v32, v33, v34
  v_max3_f32 v5, v35, v36, v37
  v_max3_f32 v4, v4, v38, v39
  v_max3_f32 v5, v5, v40, v41
  v_max3_f32 v4, v4, v42, v43
  v_max3_f32 v5, v5, v44, v45
  v_max3_f32 v4, v4, v46, v47
  v_mfma_f32_32x32x16_bf16 v[48:63], v[220:223], v[204:207], v[48:63]
  v_max_f32 v4, v4, v5
  v_cmp_lt_f32 vcc, s81, v4
  s_cbranch_vccnz P3_S11
P3_R11:
  v_exp_f32 v32, v32
  v_exp_f32 v33, v33
  v_exp_f32 v34, v34
  v_mfma_f32_32x32x16_bf16 v[64:79], v[232:235], v[160:163], v[64:79]
  v_exp_f32 v35, v35
  v_exp_f32 v36, v36
  v_exp_f32 v37, v37
  buffer_load_dwordx4 v[216:219], v0, s[4:7], s79 offen offset:0 sc1
  buffer_load_dwordx4 v[220:223], v0, s[4:7], s79 offen offset:1024 sc1
  s_add_u32 s79, s79, 4096
  v_cvt_pk_bf16_f32 v168, v32, v33
  v_cvt_pk_bf16_f32 v169, v34, v35
  v_mfma_f32_32x32x16_bf16 v[64:79], v[236:239], v[164:167], v[64:79]
  v_exp_f32 v38, v38
  v_exp_f32 v39, v39
  v_exp_f32 v40, v40
  v_exp_f32 v41, v41
  v_exp_f32 v42, v42
  v_exp_f32 v43, v43
  v_exp_f32 v44, v44
  v_exp_f32 v45, v45
  v_exp_f32 v46, v46
  v_exp_f32 v47, v47
  v_cvt_pk_bf16_f32 v170, v36, v37
  v_cvt_pk_bf16_f32 v171, v38, v39
  v_cvt_pk_bf16_f32 v172, v40, v41
  v_cvt_pk_bf16_f32 v173, v42, v43
  v_cvt_pk_bf16_f32 v174, v44, v45
  v_cvt_pk_bf16_f32 v175, v46, v47
  s_waitcnt vmcnt(4)
  v_mfma_f32_32x32x16_bf16 v[16:31], v[208:211], v[184:187], v[112:127]
  v_max3_f32 v4, v48, v49, v50
  v_max3_f32 v5, v51, v52, v53
  v_max3_f32 v4, v4, v54, v55
  v_max3_f32 v5, v5, v56, v57
  v_max3_f32 v4, v4, v58, v59
  v_max3_f32 v5, v5, v60, v61
  v_max3_f32 v4, v4, v62, v63
  v_mfma_f32_32x32x16_bf16 v[16:31], v[212:215], v[188:191], v[16:31]
  v_max_f32 v4, v4, v5
  v_cmp_lt_f32 vcc, s81, v4
  s_cbranch_vccnz P3_S12
P3_R12:
  v_exp_f32 v48, v48
  v_exp_f32 v49, v49
  v_exp_f32 v50, v50
  v_mfma_f32_32x32x16_bf16 v[80:95], v[232:235], v[168:171], v[80:95]
  v_exp_f32 v51, v51
  v_exp_f32 v52, v52
  v_exp_f32 v53, v53
  v_cvt_pk_bf16_f32 v176, v48, v49
  v_cvt_pk_bf16_f32 v177, v50, v51
  v_mfma_f32_32x32x16_bf16 v[80:95], v[236:239], v[172:175], v[80:95]
  v_exp_f32 v54, v54
  v_exp_f32 v55, v55
  v_exp_f32 v56, v56
  v_exp_f32 v57, v57
  v_exp_f32 v58, v58
  v_exp_f32 v59, v59
  v_exp_f32 v60, v60
  v_exp_f32 v61, v61
  v_exp_f32 v62, v62
  v_exp_f32 v63, v63
  v_cvt_pk_bf16_f32 v178, v52, v53
  v_cvt_pk_bf16_f32 v179, v54, v55
  v_cvt_pk_bf16_f32 v180, v56, v57
  v_cvt_pk_bf16_f32 v181, v58, v59
  v_cvt_pk_bf16_f32 v182, v60, v61
  v_cvt_pk_bf16_f32 v183, v62, v63
  s_add_u32 s83, s83, 1
  s_cmp_lt_u32 s83, 32
  s_cbranch_scc1 P3_L
  v_mfma_f32_32x32x16_bf16 v[96:111], v[232:235], v[176:179], v[96:111]
  v_mfma_f32_32x32x16_bf16 v[96:111], v[236:239], v[180:183], v[96:111]
  v_and_b32 v2, 0x1f0, v0
  s_lshr_b32 s84, s76, 2
  s_mul_i32 s84, s84, 5120
  s_add_u32 s84, s84, 4194304
  s_and_b32 s85, s76, 3
  s_lshl_b32 s85, s85, 10
  s_add_u32 s85, s85, s84
  s_and_b32 s86, s76, 2
  s_lshl_b32 s86, s86, 8
  s_add_u32 s84, s84, s86
  s_and_b32 s86, s76, 1
  s_lshl_b32 s86, s86, 3
  s_add_u32 s84, s84, s86
  s_add_u32 s84, s84, 4096
  v_rcp_f32 v4, v76
  s_nop 0
  v_mul_f32 v64, v64, v4
  v_mul_f32 v65, v65, v4
  v_mul_f32 v66, v66, v4
  v_mul_f32 v67, v67, v4
  v_mul_f32 v68, v68, v4
  v_mul_f32 v69, v69, v4
  v_mul_f32 v70, v70, v4
  v_mul_f32 v71, v71, v4
  v_mul_f32 v72, v72, v4
  v_mul_f32 v73, v73, v4
  v_mul_f32 v74, v74, v4
  v_mul_f32 v75, v75, v4
  v_cvt_pk_bf16_f32 v64, v64, v65
  v_cvt_pk_bf16_f32 v65, v66, v67
  v_cvt_pk_bf16_f32 v66, v68, v69
  v_cvt_pk_bf16_f32 v67, v70, v71
  v_cvt_pk_bf16_f32 v68, v72, v73
  v_cvt_pk_bf16_f32 v69, v74, v75
  buffer_store_dwordx4 v[64:67], v0, s[4:7], s85 offen sc1
  s_mov_b32 exec_hi, 0
  buffer_store_dwordx2 v[68:69], v0, s[4:7], s84 offen sc1
  s_mov_b32 exec_hi, -1
  s_lshr_b32 s84, s77, 2
  s_mul_i32 s84, s84, 5120
  s_add_u32 s84, s84, 4194304
  s_and_b32 s85, s77, 3
  s_lshl_b32 s85, s85, 10
  s_add_u32 s85, s85, s84
  s_and_b32 s86, s77, 2
  s_lshl_b32 s86, s86, 8
  s_add_u32 s84, s84, s86
  s_and_b32 s86, s77, 1
  s_lshl_b32 s86, s86, 3
  s_add_u32 s84, s84, s86
  s_add_u32 s84, s84, 4096
  v_rcp_f32 v4, v92
  s_nop 0
  v_mul_f32 v80, v80, v4
  v_mul_f32 v81, v81, v4
  v_mul_f32 v82, v82, v4
  v_mul_f32 v83, v83, v4
  v_mul_f32 v84, v84, v4
  v_mul_f32 v85, v85, v4
  v_mul_f32 v86, v86, v4
  v_mul_f32 v87, v87, v4
  v_mul_f32 v88, v88, v4
  v_mul_f32 v89, v89, v4
  v_mul_f32 v90, v90, v4
  v_mul_f32 v91, v91, v4
  v_cvt_pk_bf16_f32 v80, v80, v81
  v_cvt_pk_bf16_f32 v81, v82, v83
  v_cvt_pk_bf16_f32 v82, v84, v85
  v_cvt_pk_bf16_f32 v83, v86, v87
  v_cvt_pk_bf16_f32 v84, v88, v89
  v_cvt_pk_bf16_f32 v85, v90, v91
  buffer_store_dwordx4 v[80:83], v0, s[4:7], s85 offen sc1
  s_mov_b32 exec_hi, 0
  buffer_store_dwordx2 v[84:85], v0, s[4:7], s84 offen sc1
  s_mov_b32 exec_hi, -1
  s_lshr_b32 s84, s78, 2
  s_mul_i32 s84, s84, 5120
  s_add_u32 s84, s84, 4194304
  s_and_b32 s85, s78, 3
  s_lshl_b32 s85, s85, 10
  s_add_u32 s85, s85, s84
  s_and_b32 s86, s78, 2
  s_lshl_b32 s86, s86, 8
  s_add_u32 s84, s84, s86
  s_and_b32 s86, s78, 1
  s_lshl_b32 s86, s86, 3
  s_add_u32 s84, s84, s86
  s_add_u32 s84, s84, 4096
  v_rcp_f32 v4, v108
  s_nop 0
  v_mul_f32 v96, v96, v4
  v_mul_f32 v97, v97, v4
  v_mul_f32 v98, v98, v4
  v_mul_f32 v99, v99, v4
  v_mul_f32 v100, v100, v4
  v_mul_f32 v101, v101, v4
  v_mul_f32 v102, v102, v4
  v_mul_f32 v103, v103, v4
  v_mul_f32 v104, v104, v4
  v_mul_f32 v105, v105, v4
  v_mul_f32 v106, v106, v4
  v_mul_f32 v107, v107, v4
  v_cvt_pk_bf16_f32 v96, v96, v97
  v_cvt_pk_bf16_f32 v97, v98, v99
  v_cvt_pk_bf16_f32 v98, v100, v101
  v_cvt_pk_bf16_f32 v99, v102, v103
  v_cvt_pk_bf16_f32 v100, v104, v105
  v_cvt_pk_bf16_f32 v101, v106, v107
  buffer_store_dwordx4 v[96:99], v0, s[4:7], s85 offen sc1
  s_mov_b32 exec_hi, 0
  buffer_store_dwordx2 v[100:101], v0, s[4:7], s84 offen sc1
  s_mov_b32 exec_hi, -1
  s_waitcnt vmcnt(0) lgkmcnt(0)
  s_lshl_b32 s84, s76, 2
  s_add_u32 s84, s84, 8192
  v_mov_b32 v4, 1
  buffer_store_dword v4, off, s[4:7], s84 offset:0 sc1
  s_lshl_b32 s84, s77, 2
  s_add_u32 s84, s84, 8192
  v_mov_b32 v4, 1
  buffer_store_dword v4, off, s[4:7], s84 offset:0 sc1
  s_lshl_b32 s84, s78, 2
  s_add_u32 s84, s84, 8192
  v_mov_b32 v4, 1
  buffer_store_dword v4, off, s[4:7], s84 offset:0 sc1
  s_branch P3_END
P3_S00:
  v_mov_b32 v5, v4
  s_nop 1
  v_permlane32_swap_b32 v4, v5
  v_max3_f32 v4, v4, v5, s82
  v_sub_f32 v5, 0, v4
  v_min_f32 v5, 0, v5
  v_exp_f32 v5, v5
  v_sub_f32 v16, v16, v4
  v_sub_f32 v112, v112, v4
  v_mul_f32 v64, v64, v5
  v_sub_f32 v17, v17, v4
  v_sub_f32 v113, v113, v4
  v_mul_f32 v65, v65, v5
  v_sub_f32 v18, v18, v4
  v_sub_f32 v114, v114, v4
  v_mul_f32 v66, v66, v5
  v_sub_f32 v19, v19, v4
  v_sub_f32 v115, v115, v4
  v_mul_f32 v67, v67, v5
  v_sub_f32 v20, v20, v4
  v_sub_f32 v116, v116, v4
  v_mul_f32 v68, v68, v5
  v_sub_f32 v21, v21, v4
  v_sub_f32 v117, v117, v4
  v_mul_f32 v69, v69, v5
  v_sub_f32 v22, v22, v4
  v_sub_f32 v118, v118, v4
  v_mul_f32 v70, v70, v5
  v_sub_f32 v23, v23, v4
  v_sub_f32 v119, v119, v4
  v_mul_f32 v71, v71, v5
  v_sub_f32 v24, v24, v4
  v_sub_f32 v120, v120, v4
  v_mul_f32 v72, v72, v5
  v_sub_f32 v25, v25, v4
  v_sub_f32 v121, v121, v4
  v_mul_f32 v73, v73, v5
  v_sub_f32 v26, v26, v4
  v_sub_f32 v122, v122, v4
  v_mul_f32 v74, v74, v5
  v_sub_f32 v27, v27, v4
  v_sub_f32 v123, v123, v4
  v_mul_f32 v75, v75, v5
  v_sub_f32 v28, v28, v4
  v_sub_f32 v124, v124, v4
  v_mul_f32 v76, v76, v5
  v_sub_f32 v29, v29, v4
  v_sub_f32 v125, v125, v4
  v_mul_f32 v77, v77, v5
  v_sub_f32 v30, v30, v4
  v_sub_f32 v126, v126, v4
  v_mul_f32 v78, v78, v5
  v_sub_f32 v31, v31, v4
  v_sub_f32 v127, v127, v4
  v_mul_f32 v79, v79, v5
  s_branch P3_R00
P3_S01:
  v_mov_b32 v5, v4
  s_nop 1
  v_permlane32_swap_b32 v4, v5
  v_max3_f32 v4, v4, v5, s82
  v_sub_f32 v5, 0, v4
  v_min_f32 v5, 0, v5
  v_exp_f32 v5, v5
  v_sub_f32 v32, v32, v4
  v_sub_f32 v128, v128, v4
  v_mul_f32 v80, v80, v5
  v_sub_f32 v33, v33, v4
  v_sub_f32 v129, v129, v4
  v_mul_f32 v81, v81, v5
  v_sub_f32 v34, v34, v4
  v_sub_f32 v130, v130, v4
  v_mul_f32 v82, v82, v5
  v_sub_f32 v35, v35, v4
  v_sub_f32 v131, v131, v4
  v_mul_f32 v83, v83, v5
  v_sub_f32 v36, v36, v4
  v_sub_f32 v132, v132, v4
  v_mul_f32 v84, v84, v5
  v_sub_f32 v37, v37, v4
  v_sub_f32 v133, v133, v4
  v_mul_f32 v85, v85, v5
  v_sub_f32 v38, v38, v4
  v_sub_f32 v134, v134, v4
  v_mul_f32 v86, v86, v5
  v_sub_f32 v39, v39, v4
  v_sub_f32 v135, v135, v4
  v_mul_f32 v87, v87, v5
  v_sub_f32 v40, v40, v4
  v_sub_f32 v136, v136, v4
  v_mul_f32 v88, v88, v5
  v_sub_f32 v41, v41, v4
  v_sub_f32 v137, v137, v4
  v_mul_f32 v89, v89, v5
  v_sub_f32 v42, v42, v4
  v_sub_f32 v138, v138, v4
  v_mul_f32 v90, v90, v5
  v_sub_f32 v43, v43, v4
  v_sub_f32 v139, v139, v4
  v_mul_f32 v91, v91, v5
  v_sub_f32 v44, v44, v4
  v_sub_f32 v140, v140, v4
  v_mul_f32 v92, v92, v5
  v_sub_f32 v45, v45, v4
  v_sub_f32 v141, v141, v4
  v_mul_f32 v93, v93, v5
  v_sub_f32 v46, v46, v4
  v_sub_f32 v142, v142, v4
  v_mul_f32 v94, v94, v5
  v_sub_f32 v47, v47, v4
  v_sub_f32 v143, v143, v4
  v_mul_f32 v95, v95, v5
  s_branch P3_R01
P3_S02:
  v_mov_b32 v5, v4
  s_nop 1
  v_permlane32_swap_b32 v4, v5
  v_max3_f32 v4, v4, v5, s82
  v_sub_f32 v5, 0, v4
  v_min_f32 v5, 0, v5
  v_exp_f32 v5, v5
  v_sub_f32 v48, v48, v4
  v_sub_f32 v144, v144, v4
  v_mul_f32 v96, v96, v5
  v_sub_f32 v49, v49, v4
  v_sub_f32 v145, v145, v4
  v_mul_f32 v97, v97, v5
  v_sub_f32 v50, v50, v4
  v_sub_f32 v146, v146, v4
  v_mul_f32 v98, v98, v5
  v_sub_f32 v51, v51, v4
  v_sub_f32 v147, v147, v4
  v_mul_f32 v99, v99, v5
  v_sub_f32 v52, v52, v4
  v_sub_f32 v148, v148, v4
  v_mul_f32 v100, v100, v5
  v_sub_f32 v53, v53, v4
  v_sub_f32 v149, v149, v4
  v_mul_f32 v101, v101, v5
  v_sub_f32 v54, v54, v4
  v_sub_f32 v150, v150, v4
  v_mul_f32 v102, v102, v5
  v_sub_f32 v55, v55, v4
  v_sub_f32 v151, v151, v4
  v_mul_f32 v103, v103, v5
  v_sub_f32 v56, v56, v4
  v_sub_f32 v152, v152, v4
  v_mul_f32 v104, v104, v5
  v_sub_f32 v57, v57, v4
  v_sub_f32 v153, v153, v4
  v_mul_f32 v105, v105, v5
  v_sub_f32 v58, v58, v4
  v_sub_f32 v154, v154, v4
  v_mul_f32 v106, v106, v5
  v_sub_f32 v59, v59, v4
  v_sub_f32 v155, v155, v4
  v_mul_f32 v107, v107, v5
  v_sub_f32 v60, v60, v4
  v_sub_f32 v156, v156, v4
  v_mul_f32 v108, v108, v5
  v_sub_f32 v61, v61, v4
  v_sub_f32 v157, v157, v4
  v_mul_f32 v109, v109, v5
  v_sub_f32 v62, v62, v4
  v_sub_f32 v158, v158, v4
  v_mul_f32 v110, v110, v5
  v_sub_f32 v63, v63, v4
  v_sub_f32 v159, v159, v4
  v_mul_f32 v111, v111, v5
  s_branch P3_R02
P3_S10:
  v_mov_b32 v5, v4
  s_nop 1
  v_permlane32_swap_b32 v4, v5
  v_max3_f32 v4, v4, v5, s82
  v_sub_f32 v5, 0, v4
  v_min_f32 v5, 0, v5
  v_exp_f32 v5, v5
  v_sub_f32 v16, v16, v4
  v_sub_f32 v112, v112, v4
  v_mul_f32 v64, v64, v5
  v_sub_f32 v17, v17, v4
  v_sub_f32 v113, v113, v4
  v_mul_f32 v65, v65, v5
  v_sub_f32 v18, v18, v4
  v_sub_f32 v114, v114, v4
  v_mul_f32 v66, v66, v5
  v_sub_f32 v19, v19, v4
  v_sub_f32 v115, v115, v4
  v_mul_f32 v67, v67, v5
  v_sub_f32 v20, v20, v4
  v_sub_f32 v116, v116, v4
  v_mul_f32 v68, v68, v5
  v_sub_f32 v21, v21, v4
  v_sub_f32 v117, v117, v4
  v_mul_f32 v69, v69, v5
  v_sub_f32 v22, v22, v4
  v_sub_f32 v118, v118, v4
  v_mul_f32 v70, v70, v5
  v_sub_f32 v23, v23, v4
  v_sub_f32 v119, v119, v4
  v_mul_f32 v71, v71, v5
  v_sub_f32 v24, v24, v4
  v_sub_f32 v120, v120, v4
  v_mul_f32 v72, v72, v5
  v_sub_f32 v25, v25, v4
  v_sub_f32 v121, v121, v4
  v_mul_f32 v73, v73, v5
  v_sub_f32 v26, v26, v4
  v_sub_f32 v122, v122, v4
  v_mul_f32 v74, v74, v5
  v_sub_f32 v27, v27, v4
  v_sub_f32 v123, v123, v4
  v_mul_f32 v75, v75, v5
  v_sub_f32 v28, v28, v4
  v_sub_f32 v124, v124, v4
  v_mul_f32 v76, v76, v5
  v_sub_f32 v29, v29, v4
  v_sub_f32 v125, v125, v4
  v_mul_f32 v77, v77, v5
  v_sub_f32 v30, v30, v4
  v_sub_f32 v126, v126, v4
  v_mul_f32 v78, v78, v5
  v_sub_f32 v31, v31, v4
  v_sub_f32 v127, v127, v4
  v_mul_f32 v79, v79, v5
  s_branch P3_R10
P3_S11:
  v_mov_b32 v5, v4
  s_nop 1
  v_permlane32_swap_b32 v4, v5
  v_max3_f32 v4, v4, v5, s82
  v_sub_f32 v5, 0, v4
  v_min_f32 v5, 0, v5
  v_exp_f32 v5, v5
  v_sub_f32 v32, v32, v4
  v_sub_f32 v128, v128, v4
  v_mul_f32 v80, v80, v5
  v_sub_f32 v33, v33, v4
  v_sub_f32 v129, v129, v4
  v_mul_f32 v81, v81, v5
  v_sub_f32 v34, v34, v4
  v_sub_f32 v130, v130, v4
  v_mul_f32 v82, v82, v5
  v_sub_f32 v35, v35, v4
  v_sub_f32 v131, v131, v4
  v_mul_f32 v83, v83, v5
  v_sub_f32 v36, v36, v4
  v_sub_f32 v132, v132, v4
  v_mul_f32 v84, v84, v5
  v_sub_f32 v37, v37, v4
  v_sub_f32 v133, v133, v4
  v_mul_f32 v85, v85, v5
  v_sub_f32 v38, v38, v4
  v_sub_f32 v134, v134, v4
  v_mul_f32 v86, v86, v5
  v_sub_f32 v39, v39, v4
  v_sub_f32 v135, v135, v4
  v_mul_f32 v87, v87, v5
  v_sub_f32 v40, v40, v4
  v_sub_f32 v136, v136, v4
  v_mul_f32 v88, v88, v5
  v_sub_f32 v41, v41, v4
  v_sub_f32 v137, v137, v4
  v_mul_f32 v89, v89, v5
  v_sub_f32 v42, v42, v4
  v_sub_f32 v138, v138, v4
  v_mul_f32 v90, v90, v5
  v_sub_f32 v43, v43, v4
  v_sub_f32 v139, v139, v4
  v_mul_f32 v91, v91, v5
  v_sub_f32 v44, v44, v4
  v_sub_f32 v140, v140, v4
  v_mul_f32 v92, v92, v5
  v_sub_f32 v45, v45, v4
  v_sub_f32 v141, v141, v4
  v_mul_f32 v93, v93, v5
  v_sub_f32 v46, v46, v4
  v_sub_f32 v142, v142, v4
  v_mul_f32 v94, v94, v5
  v_sub_f32 v47, v47, v4
  v_sub_f32 v143, v143, v4
  v_mul_f32 v95, v95, v5
  s_branch P3_R11
P3_S12:
  v_mov_b32 v5, v4
  s_nop 1
  v_permlane32_swap_b32 v4, v5
  v_max3_f32 v4, v4, v5, s82
  v_sub_f32 v5, 0, v4
  v_min_f32 v5, 0, v5
  v_exp_f32 v5, v5
  v_sub_f32 v48, v48, v4
  v_sub_f32 v144, v144, v4
  v_mul_f32 v96, v96, v5
  v_sub_f32 v49, v49, v4
  v_sub_f32 v145, v145, v4
  v_mul_f32 v97, v97, v5
  v_sub_f32 v50, v50, v4
  v_sub_f32 v146, v146, v4
  v_mul_f32 v98, v98, v5
  v_sub_f32 v51, v51, v4
  v_sub_f32 v147, v147, v4
  v_mul_f32 v99, v99, v5
  v_sub_f32 v52, v52, v4
  v_sub_f32 v148, v148, v4
  v_mul_f32 v100, v100, v5
  v_sub_f32 v53, v53, v4
  v_sub_f32 v149, v149, v4
  v_mul_f32 v101, v101, v5
  v_sub_f32 v54, v54, v4
  v_sub_f32 v150, v150, v4
  v_mul_f32 v102, v102, v5
  v_sub_f32 v55, v55, v4
  v_sub_f32 v151, v151, v4
  v_mul_f32 v103, v103, v5
  v_sub_f32 v56, v56, v4
  v_sub_f32 v152, v152, v4
  v_mul_f32 v104, v104, v5
  v_sub_f32 v57, v57, v4
  v_sub_f32 v153, v153, v4
  v_mul_f32 v105, v105, v5
  v_sub_f32 v58, v58, v4
  v_sub_f32 v154, v154, v4
  v_mul_f32 v106, v106, v5
  v_sub_f32 v59, v59, v4
  v_sub_f32 v155, v155, v4
  v_mul_f32 v107, v107, v5
  v_sub_f32 v60, v60, v4
  v_sub_f32 v156, v156, v4
  v_mul_f32 v108, v108, v5
  v_sub_f32 v61, v61, v4
  v_sub_f32 v157, v157, v4
  v_mul_f32 v109, v109, v5
  v_sub_f32 v62, v62, v4
  v_sub_f32 v158, v158, v4
  v_mul_f32 v110, v110, v5
  v_sub_f32 v63, v63, v4
  v_sub_f32 v159, v159, v4
  v_mul_f32 v111, v111, v5
  s_branch P3_R12
P3_END:
  s_cmp_ge_u32 s73, 20
  s_cbranch_scc1 END
  s_mov_b32 s12, s56
  s_mov_b32 s13, s57
  s_mov_b32 s14, 5242880
  s_mov_b32 s15, 0x20000
  s_mov_b32 s16, s44
  s_mov_b32 s17, s45
  s_mov_b32 s18, 819200
  s_mov_b32 s19, 0x20000
  s_mov_b32 s32, s62
  s_mov_b32 s33, s63
  s_mov_b32 s34, 2621440
  s_mov_b32 s35, 0x20000
  v_mbcnt_lo_u32_b32 v1, -1, 0
  v_mbcnt_hi_u32_b32 v1, -1, v1
  s_mul_i32 s74, s3, 40960
  s_lshl_b32 s75, s73, 6
  s_mul_i32 s76, s3, 204800
  s_add_u32 s76, s76, s75
  s_mul_i32 s77, s3, 1310720
  s_add_u32 s77, s77, s75
  v_lshlrev_b32 v0, 4, v1
  v_lshrrev_b32 v8, 2, v1
  v_and_b32 v9, 3, v1
  v_mul_u32_u24 v2, 1280, v8
  v_lshl_add_u32 v2, v9, 4, v2
  v_and_b32 v8, 3, v8
  v_lshlrev_b32 v8, 6, v8
  v_lshl_add_u32 v8, v9, 3, v8
  v_bfe_u32 v9, v1, 4, 1
  v_lshl_add_u32 v8, v9, 5, v8
  v_add_u32 v8, s74, v8
  v_lshrrev_b32 v9, 5, v1
  v_lshl_add_u32 v3, v9, 8, v8
  v_mul_u32_u24 v4, 2560, v9
  v_add_u32 v4, v4, v8
  v_and_b32 v8, 31, v1
  v_mul_u32_u24 v5, 1280, v8
  v_lshl_add_u32 v5, v9, 3, v5
  v_lshlrev_b32 v6, 2, v8
  v_and_b32 v8, 7, v1
  v_bfe_u32 v9, v1, 3, 1
  v_lshlrev_b32 v7, 2, v8
  v_lshl_add_u32 v7, v9, 13, v7
  s_barrier
  s_add_u32 m0, s74, 0
  s_nop 0
  buffer_load_dwordx4 v2, s[12:15], s77 offen lds
  s_add_u32 s77, s77, 20480
  s_add_u32 m0, m0, 1024
  s_nop 0
  buffer_load_dwordx4 v2, s[12:15], s77 offen lds
  s_add_u32 s77, s77, 20480
  s_add_u32 m0, m0, 1024
  s_nop 0
  buffer_load_dwordx4 v2, s[12:15], s77 offen lds
  s_add_u32 s77, s77, 20480
  s_add_u32 m0, m0, 1024
  s_nop 0
  buffer_load_dwordx4 v2, s[12:15], s77 offen lds
  s_add_u32 s77, s77, 20480
  s_add_u32 m0, s74, 4096
  s_nop 0
  buffer_load_dwordx4 v2, s[12:15], s77 offen lds
  s_add_u32 s77, s77, 20480
  s_add_u32 m0, m0, 1024
  s_nop 0
  buffer_load_dwordx4 v2, s[12:15], s77 offen lds
  s_add_u32 s77, s77, 20480
  s_add_u32 m0, m0, 1024
  s_nop 0
  buffer_load_dwordx4 v2, s[12:15], s77 offen lds
  s_add_u32 s77, s77, 20480
  s_add_u32 m0, m0, 1024
  s_nop 0
  buffer_load_dwordx4 v2, s[12:15], s77 offen lds
  s_add_u32 s77, s77, 20480
  s_add_u32 m0, s74, 8192
  s_nop 0
  buffer_load_dwordx4 v2, s[12:15], s77 offen lds
  s_add_u32 s77, s77, 20480
  s_add_u32 m0, m0, 1024
  s_nop 0
  buffer_load_dwordx4 v2, s[12:15], s77 offen lds
  s_add_u32 s77, s77, 20480
  s_add_u32 m0, m0, 1024
  s_nop 0
  buffer_load_dwordx4 v2, s[12:15], s77 offen lds
  s_add_u32 s77, s77, 20480
  s_add_u32 m0, m0, 1024
  s_nop 0
  buffer_load_dwordx4 v2, s[12:15], s77 offen lds
  s_add_u32 s77, s77, 20480
  s_add_u32 m0, s74, 12288
  s_nop 0
  buffer_load_dwordx4 v2, s[12:15], s77 offen lds
  s_add_u32 s77, s77, 20480
  s_add_u32 m0, m0, 1024
  s_nop 0
  buffer_load_dwordx4 v2, s[12:15], s77 offen lds
  s_add_u32 s77, s77, 20480
  s_add_u32 m0, m0, 1024
  s_nop 0
  buffer_load_dwordx4 v2, s[12:15], s77 offen lds
  s_add_u32 s77, s77, 20480
  s_add_u32 m0, m0, 1024
  s_nop 0
  buffer_load_dwordx4 v2, s[12:15], s77 offen lds
  s_add_u32 s77, s77, 20480
  s_add_u32 m0, s74, 16384
  s_nop 0
  buffer_load_dwordx4 v2, s[12:15], s77 offen lds
  s_add_u32 s77, s77, 20480
  s_add_u32 m0, m0, 1024
  s_nop 0
  buffer_load_dwordx4 v2, s[12:15], s77 offen lds
  s_add_u32 s77, s77, 20480
  s_add_u32 m0, m0, 1024
  s_nop 0
  buffer_load_dwordx4 v2, s[12:15], s77 offen lds
  s_add_u32 s77, s77, 20480
  s_add_u32 m0, m0, 1024
  s_nop 0
  buffer_load_dwordx4 v2, s[12:15], s77 offen lds
  s_add_u32 s77, s77, 20480
  s_add_u32 m0, s74, 20480
  s_nop 0
  buffer_load_dwordx4 v2, s[12:15], s77 offen lds
  s_add_u32 s77, s77, 20480
  s_add_u32 m0, m0, 1024
  s_nop 0
  buffer_load_dwordx4 v2, s[12:15], s77 offen lds
  s_add_u32 s77, s77, 20480
  s_add_u32 m0, m0, 1024
  s_nop 0
  buffer_load_dwordx4 v2, s[12:15], s77 offen lds
  s_add_u32 s77, s77, 20480
  s_add_u32 m0, m0, 1024
  s_nop 0
  buffer_load_dwordx4 v2, s[12:15], s77 offen lds
  s_add_u32 s77, s77, 20480
  s_add_u32 m0, s74, 24576
  s_nop 0
  buffer_load_dwordx4 v2, s[12:15], s77 offen lds
  s_add_u32 s77, s77, 20480
  s_add_u32 m0, m0, 1024
  s_nop 0
  buffer_load_dwordx4 v2, s[12:15], s77 offen lds
  s_add_u32 s77, s77, 20480
  s_add_u32 m0, m0, 1024
  s_nop 0
  buffer_load_dwordx4 v2, s[12:15], s77 offen lds
  s_add_u32 s77, s77, 20480
  s_add_u32 m0, m0, 1024
  s_nop 0
  buffer_load_dwordx4 v2, s[12:15], s77 offen lds
  s_add_u32 s77, s77, 20480
  s_add_u32 m0, s74, 28672
  s_nop 0
  buffer_load_dwordx4 v2, s[16:19], s76 offen lds
  s_add_u32 s76, s76, 20480
  s_add_u32 m0, m0, 1024
  s_nop 0
  buffer_load_dwordx4 v2, s[16:19], s76 offen lds
  s_add_u32 s76, s76, 20480
  s_add_u32 m0, m0, 1024
  s_nop 0
  buffer_load_dwordx4 v2, s[16:19], s76 offen lds
  s_add_u32 s76, s76, 20480
  s_add_u32 m0, m0, 1024
  s_nop 0
  buffer_load_dwordx4 v2, s[16:19], s76 offen lds
  s_add_u32 s76, s76, 20480
  s_add_u32 m0, m0, 1024
  s_nop 0
  buffer_load_dwordx4 v2, s[16:19], s76 offen lds
  s_add_u32 s76, s76, 20480
  s_add_u32 m0, m0, 1024
  s_nop 0
  buffer_load_dwordx4 v2, s[16:19], s76 offen lds
  s_add_u32 s76, s76, 20480
  s_add_u32 m0, m0, 1024
  s_nop 0
  buffer_load_dwordx4 v2, s[16:19], s76 offen lds
  s_add_u32 s76, s76, 20480
  s_add_u32 m0, m0, 1024
  s_nop 0
  buffer_load_dwordx4 v2, s[16:19], s76 offen lds
  s_add_u32 s76, s76, 20480
  s_add_u32 m0, m0, 1024
  s_nop 0
  buffer_load_dwordx4 v2, s[16:19], s76 offen lds
  s_add_u32 s76, s76, 20480
  s_add_u32 m0, m0, 1024
  s_nop 0
  buffer_load_dwordx4 v2, s[16:19], s76 offen lds
  s_add_u32 s76, s76, 20480
  s_waitcnt vmcnt(34)
  ds_read_b64_tr_b16 a[0:1], v3 offset:0
  ds_read_b64_tr_b16 a[2:3], v3 offset:1024
  ds_read_b64_tr_b16 a[4:5], v3 offset:512
  ds_read_b64_tr_b16 a[6:7], v3 offset:1536
  ds_read_b64_tr_b16 a[8:9], v3 offset:2048
  ds_read_b64_tr_b16 a[10:11], v3 offset:3072
  ds_read_b64_tr_b16 a[12:13], v3 offset:2560
  ds_read_b64_tr_b16 a[14:15], v3 offset:3584
  s_waitcnt lgkmcnt(0)
  s_add_u32 m0, s74, 0
  s_nop 0
  buffer_load_dwordx4 v2, s[12:15], s77 offen lds
  s_add_u32 s77, s77, 20480
  s_add_u32 m0, m0, 1024
  s_nop 0
  buffer_load_dwordx4 v2, s[12:15], s77 offen lds
  s_add_u32 s77, s77, 20480
  s_add_u32 m0, m0, 1024
  s_nop 0
  buffer_load_dwordx4 v2, s[12:15], s77 offen lds
  s_add_u32 s77, s77, 20480
  s_add_u32 m0, m0, 1024
  s_nop 0
  buffer_load_dwordx4 v2, s[12:15], s77 offen lds
  s_add_u32 s77, s77, 20480
  s_waitcnt vmcnt(34)
  ds_read_b64_tr_b16 a[16:17], v3 offset:4096
  ds_read_b64_tr_b16 a[18:19], v3 offset:5120
  ds_read_b64_tr_b16 a[20:21], v3 offset:4608
  ds_read_b64_tr_b16 a[22:23], v3 offset:5632
  ds_read_b64_tr_b16 a[24:25], v3 offset:6144
  ds_read_b64_tr_b16 a[26:27], v3 offset:7168
  ds_read_b64_tr_b16 a[28:29], v3 offset:6656
  ds_read_b64_tr_b16 a[30:31], v3 offset:7680
  s_waitcnt lgkmcnt(0)
  s_add_u32 m0, s74, 4096
  s_nop 0
  buffer_load_dwordx4 v2, s[12:15], s77 offen lds
  s_add_u32 s77, s77, 20480
  s_add_u32 m0, m0, 1024
  s_nop 0
  buffer_load_dwordx4 v2, s[12:15], s77 offen lds
  s_add_u32 s77, s77, 20480
  s_add_u32 m0, m0, 1024
  s_nop 0
  buffer_load_dwordx4 v2, s[12:15], s77 offen lds
  s_add_u32 s77, s77, 20480
  s_add_u32 m0, m0, 1024
  s_nop 0
  buffer_load_dwordx4 v2, s[12:15], s77 offen lds
  s_add_u32 s77, s77, 20480
  s_waitcnt vmcnt(34)
  ds_read_b64_tr_b16 a[32:33], v3 offset:8192
  ds_read_b64_tr_b16 a[34:35], v3 offset:9216
  ds_read_b64_tr_b16 a[36:37], v3 offset:8704
  ds_read_b64_tr_b16 a[38:39], v3 offset:9728
  ds_read_b64_tr_b16 a[40:41], v3 offset:10240
  ds_read_b64_tr_b16 a[42:43], v3 offset:11264
  ds_read_b64_tr_b16 a[44:45], v3 offset:10752
  ds_read_b64_tr_b16 a[46:47], v3 offset:11776
  s_waitcnt lgkmcnt(0)
  s_add_u32 m0, s74, 8192
  s_nop 0
  buffer_load_dwordx4 v2, s[12:15], s77 offen lds
  s_add_u32 s77, s77, 20480
  s_add_u32 m0, m0, 1024
  s_nop 0
  buffer_load_dwordx4 v2, s[12:15], s77 offen lds
  s_add_u32 s77, s77, 20480
  s_add_u32 m0, m0, 1024
  s_nop 0
  buffer_load_dwordx4 v2, s[12:15], s77 offen lds
  s_add_u32 s77, s77, 20480
  s_add_u32 m0, m0, 1024
  s_nop 0
  buffer_load_dwordx4 v2, s[12:15], s77 offen lds
  s_add_u32 s77, s77, 20480
  s_waitcnt vmcnt(34)
  ds_read_b64_tr_b16 a[48:49], v3 offset:12288
  ds_read_b64_tr_b16 a[50:51], v3 offset:13312
  ds_read_b64_tr_b16 a[52:53], v3 offset:12800
  ds_read_b64_tr_b16 a[54:55], v3 offset:13824
  ds_read_b64_tr_b16 a[56:57], v3 offset:14336
  ds_read_b64_tr_b16 a[58:59], v3 offset:15360
  ds_read_b64_tr_b16 a[60:61], v3 offset:14848
  ds_read_b64_tr_b16 a[62:63], v3 offset:15872
  s_waitcnt lgkmcnt(0)
  s_add_u32 m0, s74, 12288
  s_nop 0
  buffer_load_dwordx4 v2, s[12:15], s77 offen lds
  s_add_u32 s77, s77, 20480
  s_add_u32 m0, m0, 1024
  s_nop 0
  buffer_load_dwordx4 v2, s[12:15], s77 offen lds
  s_add_u32 s77, s77, 20480
  s_add_u32 m0, m0, 1024
  s_nop 0
  buffer_load_dwordx4 v2, s[12:15], s77 offen lds
  s_add_u32 s77, s77, 20480
  s_add_u32 m0, m0, 1024
  s_nop 0
  buffer_load_dwordx4 v2, s[12:15], s77 offen lds
  s_add_u32 s77, s77, 20480
  s_waitcnt vmcnt(34)
  ds_read_b64_tr_b16 a[64:65], v3 offset:16384
  ds_read_b64_tr_b16 a[66:67], v3 offset:17408
  ds_read_b64_tr_b16 a[68:69], v3 offset:16896
  ds_read_b64_tr_b16 a[70:71], v3 offset:17920
  ds_read_b64_tr_b16 a[72:73], v3 offset:18432
  ds_read_b64_tr_b16 a[74:75], v3 offset:19456
  ds_read_b64_tr_b16 a[76:77], v3 offset:18944
  ds_read_b64_tr_b16 a[78:79], v3 offset:19968
  s_waitcnt lgkmcnt(0)
  s_add_u32 m0, s74, 16384
  s_nop 0
  buffer_load_dwordx4 v2, s[12:15], s77 offen lds
  s_add_u32 s77, s77, 20480
  s_add_u32 m0, m0, 1024
  s_nop 0
  buffer_load_dwordx4 v2, s[12:15], s77 offen lds
  s_add_u32 s77, s77, 20480
  s_add_u32 m0, m0, 1024
  s_nop 0
  buffer_load_dwordx4 v2, s[12:15], s77 offen lds
  s_add_u32 s77, s77, 20480
  s_add_u32 m0, m0, 1024
  s_nop 0
  buffer_load_dwordx4 v2, s[12:15], s77 offen lds
  s_add_u32 s77, s77, 20480
  s_waitcnt vmcnt(34)
  ds_read_b64_tr_b16 a[80:81], v3 offset:20480
  ds_read_b64_tr_b16 a[82:83], v3 offset:21504
  ds_read_b64_tr_b16 a[84:85], v3 offset:20992
  ds_read_b64_tr_b16 a[86:87], v3 offset:22016
  ds_read_b64_tr_b16 a[88:89], v3 offset:22528
  ds_read_b64_tr_b16 a[90:91], v3 offset:23552
  ds_read_b64_tr_b16 a[92:93], v3 offset:23040
  ds_read_b64_tr_b16 a[94:95], v3 offset:24064
  s_waitcnt lgkmcnt(0)
  s_add_u32 m0, s74, 20480
  s_nop 0
  buffer_load_dwordx4 v2, s[12:15], s77 offen lds
  s_add_u32 s77, s77, 20480
  s_add_u32 m0, m0, 1024
  s_nop 0
  buffer_load_dwordx4 v2, s[12:15], s77 offen lds
  s_add_u32 s77, s77, 20480
  s_add_u32 m0, m0, 1024
  s_nop 0
  buffer_load_dwordx4 v2, s[12:15], s77 offen lds
  s_add_u32 s77, s77, 20480
  s_add_u32 m0, m0, 1024
  s_nop 0
  buffer_load_dwordx4 v2, s[12:15], s77 offen lds
  s_add_u32 s77, s77, 20480
  s_waitcnt vmcnt(34)
  ds_read_b64_tr_b16 a[96:97], v3 offset:24576
  ds_read_b64_tr_b16 a[98:99], v3 offset:25600
  ds_read_b64_tr_b16 a[100:101], v3 offset:25088
  ds_read_b64_tr_b16 a[102:103], v3 offset:26112
  ds_read_b64_tr_b16 a[104:105], v3 offset:26624
  ds_read_b64_tr_b16 a[106:107], v3 offset:27648
  ds_read_b64_tr_b16 a[108:109], v3 offset:27136
  ds_read_b64_tr_b16 a[110:111], v3 offset:28160
  s_waitcnt lgkmcnt(0)
  s_add_u32 m0, s74, 24576
  s_nop 0
  buffer_load_dwordx4 v2, s[12:15], s77 offen lds
  s_add_u32 s77, s77, 20480
  s_add_u32 m0, m0, 1024
  s_nop 0
  buffer_load_dwordx4 v2, s[12:15], s77 offen lds
  s_add_u32 s77, s77, 20480
  s_add_u32 m0, m0, 1024
  s_nop 0
  buffer_load_dwordx4 v2, s[12:15], s77 offen lds
  s_add_u32 s77, s77, 20480
  s_add_u32 m0, m0, 1024
  s_nop 0
  buffer_load_dwordx4 v2, s[12:15], s77 offen lds
  s_add_u32 s77, s77, 20480
  s_waitcnt vmcnt(28)
  ds_read_b64_tr_b16 v[216:217], v3 offset:28672
  ds_read_b64_tr_b16 v[218:219], v3 offset:29184
  ds_read_b64_tr_b16 v[220:221], v3 offset:29952
  ds_read_b64_tr_b16 v[222:223], v3 offset:30464
  ds_read_b64_tr_b16 v[224:225], v3 offset:31232
  ds_read_b64_tr_b16 v[226:227], v3 offset:31744
  ds_read_b64_tr_b16 v[228:229], v3 offset:32512
  ds_read_b64_tr_b16 v[230:231], v3 offset:33024
  ds_read_b64_tr_b16 v[232:233], v4 offset:29696
  ds_read_b64_tr_b16 v[234:235], v4 offset:30976
  ds_read_b64_tr_b16 v[236:237], v3 offset:33792
  ds_read_b64_tr_b16 v[238:239], v3 offset:34304
  ds_read_b64_tr_b16 v[240:241], v3 offset:35072
  ds_read_b64_tr_b16 v[242:243], v3 offset:35584
  ds_read_b64_tr_b16 v[244:245], v3 offset:36352
  ds_read_b64_tr_b16 v[246:247], v3 offset:36864
  ds_read_b64_tr_b16 v[248:249], v3 offset:37632
  ds_read_b64_tr_b16 v[250:251], v3 offset:38144
  ds_read_b64_tr_b16 v[252:253], v4 offset:34816
  ds_read_b64_tr_b16 v[254:255], v4 offset:36096
  s_waitcnt lgkmcnt(0)
  s_add_u32 m0, s74, 28672
  s_nop 0
  buffer_load_dwordx4 v2, s[12:15], s77 offen lds
  s_add_u32 s77, s77, 20480
  s_add_u32 m0, m0, 1024
  s_nop 0
  buffer_load_dwordx4 v2, s[12:15], s77 offen lds
  s_add_u32 s77, s77, 20480
  s_add_u32 m0, m0, 1024
  s_nop 0
  buffer_load_dwordx4 v2, s[12:15], s77 offen lds
  s_add_u32 s77, s77, 20480
  s_add_u32 m0, m0, 1024
  s_nop 0
  buffer_load_dwordx4 v2, s[12:15], s77 offen lds
  s_add_u32 s77, s77, 20480
  s_waitcnt vmcnt(28)
  ds_read_b64_tr_b16 a[112:113], v3 offset:0
  ds_read_b64_tr_b16 a[114:115], v3 offset:1024
  ds_read_b64_tr_b16 a[116:117], v3 offset:512
  ds_read_b64_tr_b16 a[118:119], v3 offset:1536
  ds_read_b64_tr_b16 a[120:121], v3 offset:2048
  ds_read_b64_tr_b16 a[122:123], v3 offset:3072
  ds_read_b64_tr_b16 a[124:125], v3 offset:2560
  ds_read_b64_tr_b16 a[126:127], v3 offset:3584
  s_waitcnt lgkmcnt(0)
  s_add_u32 m0, s74, 0
  s_nop 0
  buffer_load_dwordx4 v2, s[12:15], s77 offen lds
  s_add_u32 s77, s77, 20480
  s_add_u32 m0, m0, 1024
  s_nop 0
  buffer_load_dwordx4 v2, s[12:15], s77 offen lds
  s_add_u32 s77, s77, 20480
  s_add_u32 m0, m0, 1024
  s_nop 0
  buffer_load_dwordx4 v2, s[12:15], s77 offen lds
  s_add_u32 s77, s77, 20480
  s_add_u32 m0, m0, 1024
  s_nop 0
  buffer_load_dwordx4 v2, s[12:15], s77 offen lds
  s_add_u32 s77, s77, 20480
  s_waitcnt vmcnt(28)
  ds_read_b64_tr_b16 a[128:129], v3 offset:4096
  ds_read_b64_tr_b16 a[130:131], v3 offset:5120
  ds_read_b64_tr_b16 a[132:133], v3 offset:4608
  ds_read_b64_tr_b16 a[134:135], v3 offset:5632
  ds_read_b64_tr_b16 a[136:137], v3 offset:6144
  ds_read_b64_tr_b16 a[138:139], v3 offset:7168
  ds_read_b64_tr_b16 a[140:141], v3 offset:6656
  ds_read_b64_tr_b16 a[142:143], v3 offset:7680
  s_waitcnt lgkmcnt(0)
  s_waitcnt vmcnt(24)
  ds_read_b64_tr_b16 a[144:145], v3 offset:8192
  ds_read_b64_tr_b16 a[146:147], v3 offset:9216
  ds_read_b64_tr_b16 a[148:149], v3 offset:8704
  ds_read_b64_tr_b16 a[150:151], v3 offset:9728
  ds_read_b64_tr_b16 a[152:153], v3 offset:10240
  ds_read_b64_tr_b16 a[154:155], v3 offset:11264
  ds_read_b64_tr_b16 a[156:157], v3 offset:10752
  ds_read_b64_tr_b16 a[158:159], v3 offset:11776
  s_waitcnt lgkmcnt(0)
  s_waitcnt vmcnt(20)
  ds_read_b64_tr_b16 a[160:161], v3 offset:12288
  ds_read_b64_tr_b16 a[162:163], v3 offset:13312
  ds_read_b64_tr_b16 a[164:165], v3 offset:12800
  ds_read_b64_tr_b16 a[166:167], v3 offset:13824
  ds_read_b64_tr_b16 a[168:169], v3 offset:14336
  ds_read_b64_tr_b16 a[170:171], v3 offset:15360
  ds_read_b64_tr_b16 a[172:173], v3 offset:14848
  ds_read_b64_tr_b16 a[174:175], v3 offset:15872
  s_waitcnt lgkmcnt(0)
  s_waitcnt vmcnt(16)
  ds_read_b64_tr_b16 a[176:177], v3 offset:16384
  ds_read_b64_tr_b16 a[178:179], v3 offset:17408
  ds_read_b64_tr_b16 a[180:181], v3 offset:16896
  ds_read_b64_tr_b16 a[182:183], v3 offset:17920
  ds_read_b64_tr_b16 a[184:185], v3 offset:18432
  ds_read_b64_tr_b16 a[186:187], v3 offset:19456
  ds_read_b64_tr_b16 a[188:189], v3 offset:18944
  ds_read_b64_tr_b16 a[190:191], v3 offset:19968
  s_waitcnt lgkmcnt(0)
  s_waitcnt vmcnt(12)
  ds_read_b64_tr_b16 a[192:193], v3 offset:20480
  ds_read_b64_tr_b16 a[194:195], v3 offset:21504
  ds_read_b64_tr_b16 a[196:197], v3 offset:20992
  ds_read_b64_tr_b16 a[198:199], v3 offset:22016
  ds_read_b64_tr_b16 a[200:201], v3 offset:22528
  ds_read_b64_tr_b16 a[202:203], v3 offset:23552
  ds_read_b64_tr_b16 a[204:205], v3 offset:23040
  ds_read_b64_tr_b16 a[206:207], v3 offset:24064
  s_waitcnt lgkmcnt(0)
  s_waitcnt vmcnt(8)
  ds_read_b64_tr_b16 a[208:209], v3 offset:24576
  ds_read_b64_tr_b16 a[210:211], v3 offset:25600
  ds_read_b64_tr_b16 a[212:213], v3 offset:25088
  ds_read_b64_tr_b16 a[214:215], v3 offset:26112
  ds_read_b64_tr_b16 a[216:217], v3 offset:26624
  ds_read_b64_tr_b16 a[218:219], v3 offset:27648
  ds_read_b64_tr_b16 a[220:221], v3 offset:27136
  ds_read_b64_tr_b16 a[222:223], v3 offset:28160
  s_waitcnt lgkmcnt(0)
  s_waitcnt vmcnt(4)
  ds_read_b64_tr_b16 a[224:225], v3 offset:28672
  ds_read_b64_tr_b16 a[226:227], v3 offset:29696
  ds_read_b64_tr_b16 a[228:229], v3 offset:29184
  ds_read_b64_tr_b16 a[230:231], v3 offset:30208
  ds_read_b64_tr_b16 a[232:233], v3 offset:30720
  ds_read_b64_tr_b16 a[234:235], v3 offset:31744
  ds_read_b64_tr_b16 a[236:237], v3 offset:31232
  ds_read_b64_tr_b16 a[238:239], v3 offset:32256
  s_waitcnt lgkmcnt(0)
  s_waitcnt vmcnt(0)
  ds_read_b64_tr_b16 a[240:241], v3 offset:0
  ds_read_b64_tr_b16 a[242:243], v3 offset:1024
  ds_read_b64_tr_b16 a[244:245], v3 offset:512
  ds_read_b64_tr_b16 a[246:247], v3 offset:1536
  ds_read_b64_tr_b16 a[248:249], v3 offset:2048
  ds_read_b64_tr_b16 a[250:251], v3 offset:3072
  ds_read_b64_tr_b16 a[252:253], v3 offset:2560
  ds_read_b64_tr_b16 a[254:255], v3 offset:3584
  s_waitcnt lgkmcnt(0)
  s_barrier
  s_lshl_b32 s74, s3, 12
  v_add_u32 v3, s74, v0
  s_lshl_b32 s74, s3, 10
  v_add_u32 v4, s74, v0
  s_lshl_b32 s74, s3, 4
  s_add_u32 s75, s75, s74
T2_L:
  s_lshl_b32 s76, s72, 2
  s_add_u32 s76, s76, s3
  s_mul_i32 s78, s76, 10240
  s_add_u32 s78, s78, 4194304
  s_lshl_b32 s77, s76, 16
  s_add_u32 s77, s77, 67108864
  s_lshl_b32 s76, s76, 5
  s_add_u32 s76, s76, 8192
  s_lshl_b32 s79, s72, 7
  s_add_u32 s79, s79, 32768
  s_mul_i32 s80, s72, 40960
  s_add_u32 s80, s80, s75
L_5:
  buffer_load_dword v8, v7, s[4:7], s76 offen sc1
  s_waitcnt vmcnt(0)
  v_cmp_ne_u32 vcc, 1, v8
  s_cbranch_vccz D_6
  s_sub_u32 s68, s68, 1
  s_cbranch_scc0 L_5
  s_mov_b32 s68, 0
D_6:
  buffer_load_dword v8, v6, s[4:7], s79 offen sc1
  buffer_load_dwordx4 v[48:51], v0, s[4:7], s78 offen offset:0 sc1
  buffer_load_dwordx4 v[52:55], v0, s[4:7], s78 offen offset:1024 sc1
  buffer_load_dwordx4 v[56:59], v0, s[4:7], s78 offen offset:2048 sc1
  buffer_load_dwordx4 v[60:63], v0, s[4:7], s78 offen offset:3072 sc1
  s_add_u32 s78, s78, 4096
  buffer_load_dwordx4 v[64:67], v0, s[4:7], s78 offen offset:0 sc1
  buffer_load_dwordx4 v[68:71], v0, s[4:7], s78 offen offset:1024 sc1
  buffer_load_dwordx4 v[72:75], v0, s[4:7], s78 offen offset:2048 sc1
  buffer_load_dwordx4 v[76:79], v0, s[4:7], s78 offen offset:3072 sc1
  s_add_u32 s78, s78, 4096
  buffer_load_dwordx4 v[80:83], v0, s[4:7], s78 offen offset:0 sc1
  buffer_load_dwordx4 v[84:87], v0, s[4:7], s78 offen offset:1024 sc1
  buffer_load_dwordx4 v[88:91], v0, s[4:7], s77 offen offset:0 sc1
  buffer_load_dwordx4 v[92:95], v0, s[4:7], s77 offen offset:1024 sc1
  buffer_load_dwordx4 v[96:99], v0, s[4:7], s77 offen offset:2048 sc1
  buffer_load_dwordx4 v[100:103], v0, s[4:7], s77 offen offset:3072 sc1
  s_add_u32 s77, s77, 4096
  buffer_load_dwordx4 v[104:107], v0, s[4:7], s77 offen offset:0 sc1
  buffer_load_dwordx4 v[108:111], v0, s[4:7], s77 offen offset:1024 sc1
  buffer_load_dwordx4 v[112:115], v0, s[4:7], s77 offen offset:2048 sc1
  buffer_load_dwordx4 v[116:119], v0, s[4:7], s77 offen offset:3072 sc1
  s_add_u32 s77, s77, 4096
  buffer_load_dwordx4 v[120:123], v0, s[4:7], s77 offen offset:0 sc1
  buffer_load_dwordx4 v[124:127], v0, s[4:7], s77 offen offset:1024 sc1
  buffer_load_dwordx4 v[128:131], v0, s[4:7], s77 offen offset:2048 sc1
  buffer_load_dwordx4 v[132:135], v0, s[4:7], s77 offen offset:3072 sc1
  s_add_u32 s77, s77, 4096
  buffer_load_dwordx4 v[136:139], v0, s[4:7], s77 offen offset:0 sc1
  buffer_load_dwordx4 v[140:143], v0, s[4:7], s77 offen offset:1024 sc1
  buffer_load_dwordx4 v[144:147], v0, s[4:7], s77 offen offset:2048 sc1
  buffer_load_dwordx4 v[148:151], v0, s[4:7], s77 offen offset:3072 sc1
  s_add_u32 s77, s77, 4096
  buffer_load_dwordx4 v[152:155], v0, s[4:7], s77 offen offset:0 sc1
  buffer_load_dwordx4 v[156:159], v0, s[4:7], s77 offen offset:1024 sc1
  buffer_load_dwordx4 v[160:163], v0, s[4:7], s77 offen offset:2048 sc1
  buffer_load_dwordx4 v[164:167], v0, s[4:7], s77 offen offset:3072 sc1
  s_add_u32 s77, s77, 4096
  buffer_load_dwordx4 v[168:171], v0, s[4:7], s77 offen offset:0 sc1
  buffer_load_dwordx4 v[172:175], v0, s[4:7], s77 offen offset:1024 sc1
  buffer_load_dwordx4 v[176:179], v0, s[4:7], s77 offen offset:2048 sc1
  buffer_load_dwordx4 v[180:183], v0, s[4:7], s77 offen offset:3072 sc1
  s_add_u32 s77, s77, 4096
  buffer_load_dwordx4 v[184:187], v0, s[4:7], s77 offen offset:0 sc1
  buffer_load_dwordx4 v[188:191], v0, s[4:7], s77 offen offset:1024 sc1
  buffer_load_dwordx4 v[192:195], v0, s[4:7], s77 offen offset:2048 sc1
  buffer_load_dwordx4 v[196:199], v0, s[4:7], s77 offen offset:3072 sc1
  s_add_u32 s77, s77, 4096
  buffer_load_dwordx4 v[200:203], v0, s[4:7], s77 offen offset:0 sc1
  buffer_load_dwordx4 v[204:207], v0, s[4:7], s77 offen offset:1024 sc1
  buffer_load_dwordx4 v[208:211], v0, s[4:7], s77 offen offset:2048 sc1
  buffer_load_dwordx4 v[212:215], v0, s[4:7], s77 offen offset:3072 sc1
  s_add_u32 s77, s77, 4096
  s_waitcnt vmcnt(41)
  v_mfma_f32_32x32x16_bf16 v[32:47], v[216:219], v[48:51], 0
  s_waitcnt vmcnt(40)
  v_mfma_f32_32x32x16_bf16 v[32:47], v[220:223], v[52:55], v[32:47]
  buffer_load_dwordx4 v[48:51], v0, s[4:7], s77 offen offset:0 sc1
  s_waitcnt vmcnt(40)
  v_mfma_f32_32x32x16_bf16 v[32:47], v[224:227], v[56:59], v[32:47]
  buffer_load_dwordx4 v[52:55], v0, s[4:7], s77 offen offset:1024 sc1
  s_waitcnt vmcnt(40)
  v_mfma_f32_32x32x16_bf16 v[32:47], v[228:231], v[60:63], v[32:47]
  buffer_load_dwordx4 v[56:59], v0, s[4:7], s77 offen offset:2048 sc1
  s_waitcnt vmcnt(40)
  v_mfma_f32_32x32x16_bf16 v[32:47], v[232:235], v[64:67], v[32:47]
  buffer_load_dwordx4 v[60:63], v0, s[4:7], s77 offen offset:3072 sc1
  s_add_u32 s77, s77, 4096
  s_waitcnt vmcnt(40)
  v_mfma_f32_32x32x16_bf16 v[32:47], v[236:239], v[68:71], v[32:47]
  buffer_load_dwordx4 v[64:67], v0, s[4:7], s77 offen offset:0 sc1
  s_waitcnt vmcnt(40)
  v_mfma_f32_32x32x16_bf16 v[32:47], v[240:243], v[72:75], v[32:47]
  buffer_load_dwordx4 v[68:71], v0, s[4:7], s77 offen offset:1024 sc1
  s_waitcnt vmcnt(40)
  v_mfma_f32_32x32x16_bf16 v[32:47], v[244:247], v[76:79], v[32:47]
  buffer_load_dwordx4 v[72:75], v0, s[4:7], s77 offen offset:2048 sc1
  s_waitcnt vmcnt(40)
  v_mfma_f32_32x32x16_bf16 v[32:47], v[248:251], v[80:83], v[32:47]
  buffer_load_dwordx4 v[76:79], v0, s[4:7], s77 offen offset:3072 sc1
  s_add_u32 s77, s77, 4096
  s_waitcnt vmcnt(40)
  v_mfma_f32_32x32x16_bf16 v[32:47], v[252:255], v[84:87], v[32:47]
  buffer_load_dwordx4 v[80:83], v0, s[4:7], s77 offen offset:0 sc1
  s_waitcnt vmcnt(40)
  v_mfma_f32_32x32x16_bf16 v[16:31], a[0:3], v[88:91], 0
  buffer_load_dwordx4 v[84:87], v0, s[4:7], s77 offen offset:1024 sc1
  s_waitcnt vmcnt(40)
  v_mfma_f32_32x32x16_bf16 v[16:31], a[4:7], v[92:95], v[16:31]
  buffer_load_dwordx4 v[88:91], v0, s[4:7], s77 offen offset:2048 sc1
  s_waitcnt vmcnt(40)
  v_mfma_f32_32x32x16_bf16 v[16:31], a[8:11], v[96:99], v[16:31]
  buffer_load_dwordx4 v[92:95], v0, s[4:7], s77 offen offset:3072 sc1
  s_add_u32 s77, s77, 4096
  s_waitcnt vmcnt(40)
  v_mfma_f32_32x32x16_bf16 v[16:31], a[12:15], v[100:103], v[16:31]
  buffer_load_dwordx4 v[96:99], v0, s[4:7], s77 offen offset:0 sc1
  s_waitcnt vmcnt(40)
  v_mfma_f32_32x32x16_bf16 v[16:31], a[16:19], v[104:107], v[16:31]
  buffer_load_dwordx4 v[100:103], v0, s[4:7], s77 offen offset:1024 sc1
  s_waitcnt vmcnt(40)
  v_mfma_f32_32x32x16_bf16 v[16:31], a[20:23], v[108:111], v[16:31]
  buffer_load_dwordx4 v[104:107], v0, s[4:7], s77 offen offset:2048 sc1
  s_waitcnt vmcnt(40)
  v_mfma_f32_32x32x16_bf16 v[16:31], a[24:27], v[112:115], v[16:31]
  buffer_load_dwordx4 v[108:111], v0, s[4:7], s77 offen offset:3072 sc1
  s_add_u32 s77, s77, 4096
  s_waitcnt vmcnt(40)
  v_mfma_f32_32x32x16_bf16 v[16:31], a[28:31], v[116:119], v[16:31]
  buffer_load_dwordx4 v[112:115], v0, s[4:7], s77 offen offset:0 sc1
  s_waitcnt vmcnt(40)
  v_mfma_f32_32x32x16_bf16 v[16:31], a[32:35], v[120:123], v[16:31]
  buffer_load_dwordx4 v[116:119], v0, s[4:7], s77 offen offset:1024 sc1
  s_waitcnt vmcnt(40)
  v_mfma_f32_32x32x16_bf16 v[16:31], a[36:39], v[124:127], v[16:31]
  buffer_load_dwordx4 v[120:123], v0, s[4:7], s77 offen offset:2048 sc1
  s_waitcnt vmcnt(40)
  v_mfma_f32_32x32x16_bf16 v[16:31], a[40:43], v[128:131], v[16:31]
  buffer_load_dwordx4 v[124:127], v0, s[4:7], s77 offen offset:3072 sc1
  s_add_u32 s77, s77, 4096
  s_waitcnt vmcnt(40)
  v_mfma_f32_32x32x16_bf16 v[16:31], a[44:47], v[132:135], v[16:31]
  buffer_load_dwordx4 v[128:131], v0, s[4:7], s77 offen offset:0 sc1
  s_waitcnt vmcnt(40)
  v_mfma_f32_32x32x16_bf16 v[16:31], a[48:51], v[136:139], v[16:31]
  buffer_load_dwordx4 v[132:135], v0, s[4:7], s77 offen offset:1024 sc1
  s_waitcnt vmcnt(40)
  v_mfma_f32_32x32x16_bf16 v[16:31], a[52:55], v[140:143], v[16:31]
  buffer_load_dwordx4 v[136:139], v0, s[4:7], s77 offen offset:2048 sc1
  s_waitcnt vmcnt(40)
  v_mfma_f32_32x32x16_bf16 v[16:31], a[56:59], v[144:147], v[16:31]
  buffer_load_dwordx4 v[140:143], v0, s[4:7], s77 offen offset:3072 sc1
  s_add_u32 s77, s77, 4096
  s_waitcnt vmcnt(40)
  v_mfma_f32_32x32x16_bf16 v[16:31], a[60:63], v[148:151], v[16:31]
  buffer_load_dwordx4 v[144:147], v0, s[4:7], s77 offen offset:0 sc1
  s_waitcnt vmcnt(40)
  v_mfma_f32_32x32x16_bf16 v[16:31], a[64:67], v[152:155], v[16:31]
  buffer_load_dwordx4 v[148:151], v0, s[4:7], s77 offen offset:1024 sc1
  s_waitcnt vmcnt(40)
  v_mfma_f32_32x32x16_bf16 v[16:31], a[68:71], v[156:159], v[16:31]
  buffer_load_dwordx4 v[152:155], v0, s[4:7], s77 offen offset:2048 sc1
  s_waitcnt vmcnt(40)
  v_mfma_f32_32x32x16_bf16 v[16:31], a[72:75], v[160:163], v[16:31]
  buffer_load_dwordx4 v[156:159], v0, s[4:7], s77 offen offset:3072 sc1
  s_add_u32 s77, s77, 4096
  s_waitcnt vmcnt(40)
  v_mfma_f32_32x32x16_bf16 v[16:31], a[76:79], v[164:167], v[16:31]
  buffer_load_dwordx4 v[160:163], v0, s[4:7], s77 offen offset:0 sc1
  s_waitcnt vmcnt(40)
  v_mfma_f32_32x32x16_bf16 v[16:31], a[80:83], v[168:171], v[16:31]
  buffer_load_dwordx4 v[164:167], v0, s[4:7], s77 offen offset:1024 sc1
  s_waitcnt vmcnt(40)
  v_mfma_f32_32x32x16_bf16 v[16:31], a[84:87], v[172:175], v[16:31]
  buffer_load_dwordx4 v[168:171], v0, s[4:7], s77 offen offset:2048 sc1
  s_waitcnt vmcnt(40)
  v_mfma_f32_32x32x16_bf16 v[16:31], a[88:91], v[176:179], v[16:31]
  buffer_load_dwordx4 v[172:175], v0, s[4:7], s77 offen offset:3072 sc1
  s_add_u32 s77, s77, 4096
  s_waitcnt vmcnt(40)
  v_mfma_f32_32x32x16_bf16 v[16:31], a[92:95], v[180:183], v[16:31]
  s_waitcnt vmcnt(39)
  v_mfma_f32_32x32x16_bf16 v[16:31], a[96:99], v[184:187], v[16:31]
  s_waitcnt vmcnt(38)
  v_mfma_f32_32x32x16_bf16 v[16:31], a[100:103], v[188:191], v[16:31]
  s_waitcnt vmcnt(37)
  v_mfma_f32_32x32x16_bf16 v[16:31], a[104:107], v[192:195], v[16:31]
  s_waitcnt vmcnt(36)
  v_mfma_f32_32x32x16_bf16 v[16:31], a[108:111], v[196:199], v[16:31]
  s_waitcnt vmcnt(35)
  v_mfma_f32_32x32x16_bf16 v[16:31], a[112:115], v[200:203], v[16:31]
  s_waitcnt vmcnt(34)
  v_mfma_f32_32x32x16_bf16 v[16:31], a[116:119], v[204:207], v[16:31]
  s_waitcnt vmcnt(33)
  v_mfma_f32_32x32x16_bf16 v[16:31], a[120:123], v[208:211], v[16:31]
  v_sub_f32 v9, 1.0, v8
  s_waitcnt vmcnt(32)
  v_mfma_f32_32x32x16_bf16 v[16:31], a[124:127], v[212:215], v[16:31]
  v_mul_f32 v32, v8, v32
  s_waitcnt vmcnt(31)
  v_mfma_f32_32x32x16_bf16 v[16:31], a[128:131], v[48:51], v[16:31]
  v_mul_f32 v33, v8, v33
  s_waitcnt vmcnt(30)
  v_mfma_f32_32x32x16_bf16 v[16:31], a[132:135], v[52:55], v[16:31]
  v_mul_f32 v34, v8, v34
  s_waitcnt vmcnt(29)
  v_mfma_f32_32x32x16_bf16 v[16:31], a[136:139], v[56:59], v[16:31]
  v_mul_f32 v35, v8, v35
  s_waitcnt vmcnt(28)
  v_mfma_f32_32x32x16_bf16 v[16:31], a[140:143], v[60:63], v[16:31]
  v_mul_f32 v36, v8, v36
  s_waitcnt vmcnt(27)
  v_mfma_f32_32x32x16_bf16 v[16:31], a[144:147], v[64:67], v[16:31]
  v_mul_f32 v37, v8, v37
  s_waitcnt vmcnt(26)
  v_mfma_f32_32x32x16_bf16 v[16:31], a[148:151], v[68:71], v[16:31]
  v_mul_f32 v38, v8, v38
  s_waitcnt vmcnt(25)
  v_mfma_f32_32x32x16_bf16 v[16:31], a[152:155], v[72:75], v[16:31]
  v_mul_f32 v39, v8, v39
  s_waitcnt vmcnt(24)
  v_mfma_f32_32x32x16_bf16 v[16:31], a[156:159], v[76:79], v[16:31]
  v_mul_f32 v40, v8, v40
  s_waitcnt vmcnt(23)
  v_mfma_f32_32x32x16_bf16 v[16:31], a[160:163], v[80:83], v[16:31]
  v_mul_f32 v41, v8, v41
  s_waitcnt vmcnt(22)
  v_mfma_f32_32x32x16_bf16 v[16:31], a[164:167], v[84:87], v[16:31]
  v_mul_f32 v42, v8, v42
  s_waitcnt vmcnt(21)
  v_mfma_f32_32x32x16_bf16 v[16:31], a[168:171], v[88:91], v[16:31]
  v_mul_f32 v43, v8, v43
  s_waitcnt vmcnt(20)
  v_mfma_f32_32x32x16_bf16 v[16:31], a[172:175], v[92:95], v[16:31]
  v_mul_f32 v44, v8, v44
  s_waitcnt vmcnt(19)
  v_mfma_f32_32x32x16_bf16 v[16:31], a[176:179], v[96:99], v[16:31]
  v_mul_f32 v45, v8, v45
  s_waitcnt vmcnt(18)
  v_mfma_f32_32x32x16_bf16 v[16:31], a[180:183], v[100:103], v[16:31]
  v_mul_f32 v46, v8, v46
  s_waitcnt vmcnt(17)
  v_mfma_f32_32x32x16_bf16 v[16:31], a[184:187], v[104:107], v[16:31]
  v_mul_f32 v47, v8, v47
  s_waitcnt vmcnt(16)
  v_mfma_f32_32x32x16_bf16 v[16:31], a[188:191], v[108:111], v[16:31]
  s_waitcnt vmcnt(15)
  v_mfma_f32_32x32x16_bf16 v[16:31], a[192:195], v[112:115], v[16:31]
  s_waitcnt vmcnt(14)
  v_mfma_f32_32x32x16_bf16 v[16:31], a[196:199], v[116:119], v[16:31]
  s_waitcnt vmcnt(13)
  v_mfma_f32_32x32x16_bf16 v[16:31], a[200:203], v[120:123], v[16:31]
  s_waitcnt vmcnt(12)
  v_mfma_f32_32x32x16_bf16 v[16:31], a[204:207], v[124:127], v[16:31]
  s_waitcnt vmcnt(11)
  v_mfma_f32_32x32x16_bf16 v[16:31], a[208:211], v[128:131], v[16:31]
  s_waitcnt vmcnt(10)
  v_mfma_f32_32x32x16_bf16 v[16:31], a[212:215], v[132:135], v[16:31]
  s_waitcnt vmcnt(9)
  v_mfma_f32_32x32x16_bf16 v[16:31], a[216:219], v[136:139], v[16:31]
  s_waitcnt vmcnt(8)
  v_mfma_f32_32x32x16_bf16 v[16:31], a[220:223], v[140:143], v[16:31]
  s_waitcnt vmcnt(7)
  v_mfma_f32_32x32x16_bf16 v[16:31], a[224:227], v[144:147], v[16:31]
  s_waitcnt vmcnt(6)
  v_mfma_f32_32x32x16_bf16 v[16:31], a[228:231], v[148:151], v[16:31]
  s_waitcnt vmcnt(5)
  v_mfma_f32_32x32x16_bf16 v[16:31], a[232:235], v[152:155], v[16:31]
  s_waitcnt vmcnt(4)
  v_mfma_f32_32x32x16_bf16 v[16:31], a[236:239], v[156:159], v[16:31]
  s_waitcnt vmcnt(3)
  v_mfma_f32_32x32x16_bf16 v[16:31], a[240:243], v[160:163], v[16:31]
  s_waitcnt vmcnt(2)
  v_mfma_f32_32x32x16_bf16 v[16:31], a[244:247], v[164:167], v[16:31]
  s_waitcnt vmcnt(1)
  v_mfma_f32_32x32x16_bf16 v[16:31], a[248:251], v[168:171], v[16:31]
  s_waitcnt vmcnt(0)
  v_mfma_f32_32x32x16_bf16 v[16:31], a[252:255], v[172:175], v[16:31]
  s_nop 7
  s_nop 3
  v_fmac_f32 v32, v9, v16
  v_fmac_f32 v33, v9, v17
  v_fmac_f32 v34, v9, v18
  v_fmac_f32 v35, v9, v19
  ds_write_b128 v3, v[32:35] offset:0
  v_fmac_f32 v36, v9, v20
  v_fmac_f32 v37, v9, v21
  v_fmac_f32 v38, v9, v22
  v_fmac_f32 v39, v9, v23
  ds_write_b128 v3, v[36:39] offset:1024
  v_fmac_f32 v40, v9, v24
  v_fmac_f32 v41, v9, v25
  v_fmac_f32 v42, v9, v26
  v_fmac_f32 v43, v9, v27
  ds_write_b128 v3, v[40:43] offset:2048
  v_fmac_f32 v44, v9, v28
  v_fmac_f32 v45, v9, v29
  v_fmac_f32 v46, v9, v30
  v_fmac_f32 v47, v9, v31
  ds_write_b128 v3, v[44:47] offset:3072
  s_waitcnt lgkmcnt(0)
  s_barrier
  ds_read_b128 v[16:19], v4 offset:0
  ds_read_b128 v[20:23], v4 offset:4096
  ds_read_b128 v[24:27], v4 offset:8192
  ds_read_b128 v[28:31], v4 offset:12288
  v_xor_b32 v3, 0x4000, v3
  v_xor_b32 v4, 0x4000, v4
  s_waitcnt lgkmcnt(0)
  v_pk_add_f32 v[16:17], v[16:17], v[20:21]
  v_pk_add_f32 v[18:19], v[18:19], v[22:23]
  v_pk_add_f32 v[24:25], v[24:25], v[28:29]
  v_pk_add_f32 v[26:27], v[26:27], v[30:31]
  v_pk_add_f32 v[16:17], v[16:17], v[24:25]
  v_pk_add_f32 v[18:19], v[18:19], v[26:27]
  v_cvt_pk_bf16_f32 v10, v16, v17
  v_cvt_pk_bf16_f32 v11, v18, v19
  buffer_store_dwordx2 v[10:11], v5, s[32:35], s80 offen
  s_add_u32 s72, s72, 7
  s_cmp_lt_u32 s72, 64
  s_cbranch_scc1 T2_L
  s_branch END
T1:
  v_mbcnt_lo_u32_b32 v1, -1, 0
  v_mbcnt_hi_u32_b32 v1, -1, v1
  s_lshr_b32 s72, s74, 3
  s_and_b32 s73, s74, 7
  s_lshl_b32 s73, s73, 2
  s_add_u32 s73, s73, s3
  v_lshlrev_b32 v0, 4, v1
  s_lshr_b32 s75, s73, 1
  s_add_u32 s75, s75, 32
  s_sub_u32 s75, s75, s73
  v_bfe_u32 v2, v1, 2, 1
  v_mul_lo_u32 v2, v2, s75
  v_and_b32 v3, 3, v1
  v_lshl_add_u32 v2, v2, 2, v3
  v_lshlrev_b32 v2, 2, v2
  s_lshl_b32 s75, s73, 4
L_7:
  buffer_load_dword v3, v2, s[4:7], s75 offen sc1
  s_waitcnt vmcnt(0)
  v_cmp_ne_u32 vcc, 16, v3
  s_cbranch_vccz D_8
  s_sub_u32 s68, s68, 1
  s_cbranch_scc0 L_7
  s_mov_b32 s68, 0
D_8:
  v_and_b32 v2, 15, v1
  v_lshrrev_b32 v3, 4, v1
  v_lshlrev_b32 v4, 4, v2
  v_lshl_add_u32 v4, v3, 9, v4
  v_lshlrev_b32 v3, 2, v3
  v_sub_u32 v2, v2, v3
  v_mov_b32 v5, 0xff800000
  s_mov_b32 s94, 0x3e0293ee
  s_lshl_b32 s81, s73, 7
  s_add_u32 s81, s81, 4108
  v_cmp_le_i32 s[84:85], 0, v2
  v_mov_b32 v8, 0x3f803f80
  v_cmp_le_i32 s[86:87], 1, v2
  v_mov_b32 v9, 0x3f803f80
  v_cmp_le_i32 s[88:89], 2, v2
  v_mov_b32 v10, 0x3f803f80
  v_cmp_le_i32 s[90:91], 3, v2
  v_mov_b32 v11, 0x3f803f80
  v_or_b32 v1, 0x80, v0
  v_mov_b32 v2, 0
  v_mov_b32 v12, 0x3f003f00
  v_mov_b32 v13, 0x3f003f00
T1_L:
  s_lshl_b32 s75, s72, 5
  s_add_u32 s75, s75, s73
  s_lshl_b32 s80, s75, 2
  s_add_u32 s80, s80, 16384
  s_lshl_b32 s76, s75, 14
  s_add_u32 s76, s76, 16777216
  s_lshl_b32 s75, s75, 13
  s_add_u32 s77, s75, 50331648
  s_add_u32 s78, s75, 83886080
  s_add_u32 s79, s75, 67108864
  buffer_load_dwordx4 v[16:19], v0, s[4:7], s77 offen offset:0 sc1
  buffer_load_dwordx4 v[48:51], v0, s[4:7], s76 offen offset:0 sc1
  buffer_load_dwordx4 v[80:83], v0, s[4:7], s76 offen offset:2048 sc1
  buffer_load_dwordx4 v[20:23], v0, s[4:7], s77 offen offset:1024 sc1
  buffer_load_dwordx4 v[52:55], v0, s[4:7], s76 offen offset:1024 sc1
  buffer_load_dwordx4 v[84:87], v0, s[4:7], s76 offen offset:3072 sc1
  s_add_u32 s76, s76, 4096
  buffer_load_dwordx4 v[24:27], v0, s[4:7], s77 offen offset:2048 sc1
  buffer_load_dwordx4 v[56:59], v0, s[4:7], s76 offen offset:0 sc1
  buffer_load_dwordx4 v[88:91], v0, s[4:7], s76 offen offset:2048 sc1
  buffer_load_dwordx4 v[28:31], v0, s[4:7], s77 offen offset:3072 sc1
  buffer_load_dwordx4 v[60:63], v0, s[4:7], s76 offen offset:1024 sc1
  buffer_load_dwordx4 v[92:95], v0, s[4:7], s76 offen offset:3072 sc1
  s_add_u32 s76, s76, 4096
  s_add_u32 s77, s77, 4096
  buffer_load_dwordx4 v[32:35], v0, s[4:7], s77 offen offset:0 sc1
  buffer_load_dwordx4 v[64:67], v0, s[4:7], s76 offen offset:0 sc1
  buffer_load_dwordx4 v[96:99], v0, s[4:7], s76 offen offset:2048 sc1
  buffer_load_dwordx4 v[36:39], v0, s[4:7], s77 offen offset:1024 sc1
  buffer_load_dwordx4 v[68:71], v0, s[4:7], s76 offen offset:1024 sc1
  buffer_load_dwordx4 v[100:103], v0, s[4:7], s76 offen offset:3072 sc1
  s_add_u32 s76, s76, 4096
  buffer_load_dwordx4 v[40:43], v0, s[4:7], s77 offen offset:2048 sc1
  buffer_load_dwordx4 v[72:75], v0, s[4:7], s76 offen offset:0 sc1
  buffer_load_dwordx4 v[104:107], v0, s[4:7], s76 offen offset:2048 sc1
  buffer_load_dwordx4 v[44:47], v0, s[4:7], s77 offen offset:3072 sc1
  buffer_load_dwordx4 v[76:79], v0, s[4:7], s76 offen offset:1024 sc1
  buffer_load_dwordx4 v[108:111], v0, s[4:7], s76 offen offset:3072 sc1
  s_add_u32 s76, s76, 4096
L_9:
  buffer_load_dword v3, v2, s[4:7], s81 offen sc1
  s_waitcnt vmcnt(0)
  v_cmp_ge_u32 vcc, s72, v3
  s_cbranch_vccz D_10
  s_sub_u32 s68, s68, 1
  s_cbranch_scc0 L_9
  s_mov_b32 s68, 0
D_10:
  buffer_load_dwordx4 v[112:115], v1, s[4:7], s78 offen offset:0 sc1
  buffer_load_dwordx4 v[128:131], v0, s[4:7], s78 offen offset:1024 sc1
  buffer_load_dwordx4 v[116:119], v1, s[4:7], s78 offen offset:2048 sc1
  buffer_load_dwordx4 v[132:135], v0, s[4:7], s78 offen offset:3072 sc1
  s_add_u32 s78, s78, 4096
  buffer_load_dwordx4 v[120:123], v1, s[4:7], s78 offen offset:0 sc1
  buffer_load_dwordx4 v[136:139], v0, s[4:7], s78 offen offset:1024 sc1
  buffer_load_dwordx4 v[124:127], v1, s[4:7], s78 offen offset:2048 sc1
  buffer_load_dwordx4 v[140:143], v0, s[4:7], s78 offen offset:3072 sc1
  v_mfma_f32_16x16x32_bf16 v[144:147], v[48:51], v[16:19], 0
  v_mfma_f32_16x16x32_bf16 v[156:159], v[48:51], v[20:23], 0
  v_mfma_f32_16x16x32_bf16 v[160:163], v[52:55], v[20:23], 0
  v_mfma_f32_16x16x32_bf16 v[144:147], v[56:59], v[24:27], v[144:147]
  v_mfma_f32_16x16x32_bf16 v[156:159], v[56:59], v[28:31], v[156:159]
  v_mfma_f32_16x16x32_bf16 v[160:163], v[60:63], v[28:31], v[160:163]
  v_mfma_f32_16x16x32_bf16 v[144:147], v[64:67], v[32:35], v[144:147]
  v_mfma_f32_16x16x32_bf16 v[156:159], v[64:67], v[36:39], v[156:159]
  v_mfma_f32_16x16x32_bf16 v[160:163], v[68:71], v[36:39], v[160:163]
  v_mfma_f32_16x16x32_bf16 v[144:147], v[72:75], v[40:43], v[144:147]
  v_mfma_f32_16x16x32_bf16 v[156:159], v[72:75], v[44:47], v[156:159]
  v_mfma_f32_16x16x32_bf16 v[160:163], v[76:79], v[44:47], v[160:163]
  s_nop 5
  v_cndmask_b32 v144, v5, v144, s[84:85]
  v_cndmask_b32 v145, v5, v145, s[86:87]
  v_cndmask_b32 v146, v5, v146, s[88:89]
  v_cndmask_b32 v147, v5, v147, s[90:91]
  v_cndmask_b32 v160, v5, v160, s[84:85]
  v_cndmask_b32 v161, v5, v161, s[86:87]
  v_cndmask_b32 v162, v5, v162, s[88:89]
  v_cndmask_b32 v163, v5, v163, s[90:91]
  s_waitcnt vmcnt(0)
  v_mfma_f32_16x16x32_bf16 v[152:155], v[112:115], v[16:19], 0
  v_mfma_f32_16x16x32_bf16 v[164:167], v[112:115], v[20:23], 0
  v_mfma_f32_16x16x32_bf16 v[152:155], v[116:119], v[24:27], v[152:155]
  v_mfma_f32_16x16x32_bf16 v[164:167], v[116:119], v[28:31], v[164:167]
  v_mfma_f32_16x16x32_bf16 v[152:155], v[120:123], v[32:35], v[152:155]
  v_mfma_f32_16x16x32_bf16 v[164:167], v[120:123], v[36:39], v[164:167]
  v_mfma_f32_16x16x32_bf16 v[152:155], v[124:127], v[40:43], v[152:155]
  v_mfma_f32_16x16x32_bf16 v[164:167], v[124:127], v[44:47], v[164:167]
  v_max_f32 v6, v144, v145
  v_max3_f32 v6, v6, v146, v147
  s_nop 4
  v_max3_f32 v6, v6, v152, v153
  v_max3_f32 v6, v6, v154, v155
  v_max_f32 v14, v156, v157
  v_max3_f32 v14, v14, v158, v159
  v_max3_f32 v14, v14, v160, v161
  v_max3_f32 v14, v14, v162, v163
  v_max3_f32 v14, v14, v164, v165
  v_max3_f32 v14, v14, v166, v167
  v_mov_b32 v7, v6
  v_mov_b32 v15, v14
  s_nop 0
  v_permlane16_swap_b32 v6, v7
  v_permlane16_swap_b32 v14, v15
  v_max_f32 v6, v6, v7
  v_max_f32 v14, v14, v15
  v_mov_b32 v7, v6
  v_mov_b32 v15, v14
  s_nop 0
  v_permlane32_swap_b32 v6, v7
  v_permlane32_swap_b32 v14, v15
  v_max_f32 v6, v6, v7
  v_max_f32 v14, v14, v15
  v_mul_f32 v6, s94, v6
  v_mul_f32 v14, s94, v14
  v_mov_b64 v[170:171], 0
  v_fma_f32 v144, v144, s94, -v6
  v_fma_f32 v145, v145, s94, -v6
  v_fma_f32 v146, v146, s94, -v6
  v_fma_f32 v147, v147, s94, -v6
  v_fma_f32 v152, v152, s94, -v6
  v_fma_f32 v153, v153, s94, -v6
  v_fma_f32 v154, v154, s94, -v6
  v_fma_f32 v155, v155, s94, -v6
  v_exp_f32 v144, v144
  v_exp_f32 v145, v145
  v_exp_f32 v146, v146
  v_exp_f32 v147, v147
  v_exp_f32 v152, v152
  v_exp_f32 v153, v153
  v_exp_f32 v154, v154
  v_exp_f32 v155, v155
  v_fma_f32 v156, v156, s94, -v14
  v_fma_f32 v157, v157, s94, -v14
  v_fma_f32 v158, v158, s94, -v14
  v_fma_f32 v159, v159, s94, -v14
  v_fma_f32 v160, v160, s94, -v14
  v_fma_f32 v161, v161, s94, -v14
  v_fma_f32 v162, v162, s94, -v14
  v_fma_f32 v163, v163, s94, -v14
  v_fma_f32 v164, v164, s94, -v14
  v_fma_f32 v165, v165, s94, -v14
  v_fma_f32 v166, v166, s94, -v14
  v_fma_f32 v167, v167, s94, -v14
  v_exp_f32 v156, v156
  v_exp_f32 v157, v157
  v_exp_f32 v158, v158
  v_exp_f32 v159, v159
  v_exp_f32 v160, v160
  v_exp_f32 v161, v161
  v_exp_f32 v162, v162
  v_exp_f32 v163, v163
  v_exp_f32 v164, v164
  v_exp_f32 v165, v165
  v_exp_f32 v166, v166
  v_exp_f32 v167, v167
  v_cvt_pk_bf16_f32 v168, v144, v145
  v_cvt_pk_bf16_f32 v169, v146, v147
  v_cvt_pk_bf16_f32 v176, v152, v153
  v_cvt_pk_bf16_f32 v177, v154, v155
  v_cvt_pk_bf16_f32 v172, v156, v157
  v_cvt_pk_bf16_f32 v173, v158, v159
  v_cvt_pk_bf16_f32 v174, v160, v161
  v_cvt_pk_bf16_f32 v175, v162, v163
  v_cvt_pk_bf16_f32 v178, v164, v165
  v_cvt_pk_bf16_f32 v179, v166, v167
  v_mfma_f32_16x16x32_bf16 v[180:183], v[8:11], v[168:171], 0
  v_mfma_f32_16x16x32_bf16 v[184:187], v[8:11], v[172:175], 0
  v_mfma_f32_16x16x16_bf16 v[180:183], v[12:13], v[176:177], v[180:183]
  v_mfma_f32_16x16x16_bf16 v[184:187], v[12:13], v[178:179], v[184:187]
  v_mfma_f32_16x16x32_bf16 v[192:195], v[80:83], v[168:171], 0
  v_mfma_f32_16x16x32_bf16 v[196:199], v[84:87], v[168:171], 0
  v_mfma_f32_16x16x32_bf16 v[200:203], v[80:83], v[172:175], 0
  v_mfma_f32_16x16x32_bf16 v[204:207], v[84:87], v[172:175], 0
  v_mfma_f32_16x16x16_bf16 v[192:195], v[128:129], v[176:177], v[192:195]
  v_mfma_f32_16x16x16_bf16 v[196:199], v[130:131], v[176:177], v[196:199]
  v_mfma_f32_16x16x16_bf16 v[200:203], v[128:129], v[178:179], v[200:203]
  v_mfma_f32_16x16x16_bf16 v[204:207], v[130:131], v[178:179], v[204:207]
  v_rcp_f32 v6, v180
  v_rcp_f32 v14, v184
  v_mfma_f32_16x16x32_bf16 v[208:211], v[88:91], v[168:171], 0
  v_mfma_f32_16x16x32_bf16 v[212:215], v[92:95], v[168:171], 0
  v_mfma_f32_16x16x32_bf16 v[216:219], v[88:91], v[172:175], 0
  v_mfma_f32_16x16x32_bf16 v[220:223], v[92:95], v[172:175], 0
  v_mfma_f32_16x16x16_bf16 v[208:211], v[132:133], v[176:177], v[208:211]
  v_mfma_f32_16x16x16_bf16 v[212:215], v[134:135], v[176:177], v[212:215]
  v_mfma_f32_16x16x16_bf16 v[216:219], v[132:133], v[178:179], v[216:219]
  v_mfma_f32_16x16x16_bf16 v[220:223], v[134:135], v[178:179], v[220:223]
  v_mul_f32 v192, v192, v6
  v_mul_f32 v193, v193, v6
  v_mul_f32 v194, v194, v6
  v_mul_f32 v195, v195, v6
  v_mul_f32 v196, v196, v6
  v_mul_f32 v197, v197, v6
  v_mul_f32 v198, v198, v6
  v_mul_f32 v199, v199, v6
  v_cvt_pk_bf16_f32 v192, v192, v193
  v_cvt_pk_bf16_f32 v193, v194, v195
  v_cvt_pk_bf16_f32 v194, v196, v197
  v_cvt_pk_bf16_f32 v195, v198, v199
  buffer_store_dwordx4 v[192:195], v4, s[4:7], s79 offen offset:0 sc1
  v_mul_f32 v200, v200, v14
  v_mul_f32 v201, v201, v14
  v_mul_f32 v202, v202, v14
  v_mul_f32 v203, v203, v14
  v_mul_f32 v204, v204, v14
  v_mul_f32 v205, v205, v14
  v_mul_f32 v206, v206, v14
  v_mul_f32 v207, v207, v14
  v_cvt_pk_bf16_f32 v200, v200, v201
  v_cvt_pk_bf16_f32 v201, v202, v203
  v_cvt_pk_bf16_f32 v202, v204, v205
  v_cvt_pk_bf16_f32 v203, v206, v207
  buffer_store_dwordx4 v[200:203], v4, s[4:7], s79 offen offset:256 sc1
  v_mfma_f32_16x16x32_bf16 v[224:227], v[96:99], v[168:171], 0
  v_mfma_f32_16x16x32_bf16 v[228:231], v[100:103], v[168:171], 0
  v_mfma_f32_16x16x32_bf16 v[232:235], v[96:99], v[172:175], 0
  v_mfma_f32_16x16x32_bf16 v[236:239], v[100:103], v[172:175], 0
  v_mfma_f32_16x16x16_bf16 v[224:227], v[136:137], v[176:177], v[224:227]
  v_mfma_f32_16x16x16_bf16 v[228:231], v[138:139], v[176:177], v[228:231]
  v_mfma_f32_16x16x16_bf16 v[232:235], v[136:137], v[178:179], v[232:235]
  v_mfma_f32_16x16x16_bf16 v[236:239], v[138:139], v[178:179], v[236:239]
  v_mul_f32 v208, v208, v6
  v_mul_f32 v209, v209, v6
  v_mul_f32 v210, v210, v6
  v_mul_f32 v211, v211, v6
  v_mul_f32 v212, v212, v6
  v_mul_f32 v213, v213, v6
  v_mul_f32 v214, v214, v6
  v_mul_f32 v215, v215, v6
  v_cvt_pk_bf16_f32 v208, v208, v209
  v_cvt_pk_bf16_f32 v209, v210, v211
  v_cvt_pk_bf16_f32 v210, v212, v213
  v_cvt_pk_bf16_f32 v211, v214, v215
  buffer_store_dwordx4 v[208:211], v4, s[4:7], s79 offen offset:2048 sc1
  v_mul_f32 v216, v216, v14
  v_mul_f32 v217, v217, v14
  v_mul_f32 v218, v218, v14
  v_mul_f32 v219, v219, v14
  v_mul_f32 v220, v220, v14
  v_mul_f32 v221, v221, v14
  v_mul_f32 v222, v222, v14
  v_mul_f32 v223, v223, v14
  v_cvt_pk_bf16_f32 v216, v216, v217
  v_cvt_pk_bf16_f32 v217, v218, v219
  v_cvt_pk_bf16_f32 v218, v220, v221
  v_cvt_pk_bf16_f32 v219, v222, v223
  buffer_store_dwordx4 v[216:219], v4, s[4:7], s79 offen offset:2304 sc1
  s_add_u32 s79, s79, 4096
  v_mfma_f32_16x16x32_bf16 v[240:243], v[104:107], v[168:171], 0
  v_mfma_f32_16x16x32_bf16 v[244:247], v[108:111], v[168:171], 0
  v_mfma_f32_16x16x32_bf16 v[248:251], v[104:107], v[172:175], 0
  v_mfma_f32_16x16x32_bf16 v[252:255], v[108:111], v[172:175], 0
  v_mfma_f32_16x16x16_bf16 v[240:243], v[140:141], v[176:177], v[240:243]
  v_mfma_f32_16x16x16_bf16 v[244:247], v[142:143], v[176:177], v[244:247]
  v_mfma_f32_16x16x16_bf16 v[248:251], v[140:141], v[178:179], v[248:251]
  v_mfma_f32_16x16x16_bf16 v[252:255], v[142:143], v[178:179], v[252:255]
  v_mul_f32 v224, v224, v6
  v_mul_f32 v225, v225, v6
  v_mul_f32 v226, v226, v6
  v_mul_f32 v227, v227, v6
  v_mul_f32 v228, v228, v6
  v_mul_f32 v229, v229, v6
  v_mul_f32 v230, v230, v6
  v_mul_f32 v231, v231, v6
  v_cvt_pk_bf16_f32 v224, v224, v225
  v_cvt_pk_bf16_f32 v225, v226, v227
  v_cvt_pk_bf16_f32 v226, v228, v229
  v_cvt_pk_bf16_f32 v227, v230, v231
  buffer_store_dwordx4 v[224:227], v4, s[4:7], s79 offen offset:0 sc1
  v_mul_f32 v232, v232, v14
  v_mul_f32 v233, v233, v14
  v_mul_f32 v234, v234, v14
  v_mul_f32 v235, v235, v14
  v_mul_f32 v236, v236, v14
  v_mul_f32 v237, v237, v14
  v_mul_f32 v238, v238, v14
  v_mul_f32 v239, v239, v14
  v_cvt_pk_bf16_f32 v232, v232, v233
  v_cvt_pk_bf16_f32 v233, v234, v235
  v_cvt_pk_bf16_f32 v234, v236, v237
  v_cvt_pk_bf16_f32 v235, v238, v239
  buffer_store_dwordx4 v[232:235], v4, s[4:7], s79 offen offset:256 sc1
  v_mul_f32 v240, v240, v6
  v_mul_f32 v241, v241, v6
  v_mul_f32 v242, v242, v6
  v_mul_f32 v243, v243, v6
  v_mul_f32 v244, v244, v6
  v_mul_f32 v245, v245, v6
  v_mul_f32 v246, v246, v6
  v_mul_f32 v247, v247, v6
  v_cvt_pk_bf16_f32 v240, v240, v241
  v_cvt_pk_bf16_f32 v241, v242, v243
  v_cvt_pk_bf16_f32 v242, v244, v245
  v_cvt_pk_bf16_f32 v243, v246, v247
  buffer_store_dwordx4 v[240:243], v4, s[4:7], s79 offen offset:2048 sc1
  v_mul_f32 v248, v248, v14
  v_mul_f32 v249, v249, v14
  v_mul_f32 v250, v250, v14
  v_mul_f32 v251, v251, v14
  v_mul_f32 v252, v252, v14
  v_mul_f32 v253, v253, v14
  v_mul_f32 v254, v254, v14
  v_mul_f32 v255, v255, v14
  v_cvt_pk_bf16_f32 v248, v248, v249
  v_cvt_pk_bf16_f32 v249, v250, v251
  v_cvt_pk_bf16_f32 v250, v252, v253
  v_cvt_pk_bf16_f32 v251, v254, v255
  buffer_store_dwordx4 v[248:251], v4, s[4:7], s79 offen offset:2304 sc1
  s_waitcnt vmcnt(0) lgkmcnt(0)
  v_mov_b32 v3, 1
  buffer_store_dword v3, off, s[4:7], s80 offset:0 sc1
  s_add_u32 s72, s72, 4
  s_cmp_lt_u32 s72, 64
  s_cbranch_scc1 T1_L
  s_branch END
CHAIN:
  s_mov_b32 s12, s50
  s_mov_b32 s13, s51
  s_mov_b32 s14, 5242880
  s_mov_b32 s15, 0x20000
  s_mov_b32 s16, s52
  s_mov_b32 s17, s53
  s_mov_b32 s18, 5242880
  s_mov_b32 s19, 0x20000
  s_mov_b32 s20, s54
  s_mov_b32 s21, s55
  s_mov_b32 s22, 5242880
  s_mov_b32 s23, 0x20000
  s_mov_b32 s24, s56
  s_mov_b32 s25, s57
  s_mov_b32 s26, 5242880
  s_mov_b32 s27, 0x20000
  s_mov_b32 s32, s48
  s_mov_b32 s33, s49
  s_mov_b32 s34, 10240
  s_mov_b32 s35, 0x20000
  s_mul_i32 s83, s3, 36864
  s_add_u32 s83, s83, 16384
  s_lshl_b32 s84, s3, 12
  s_lshl_b32 s85, s69, 2
  s_add_u32 s85, s85, s3
  s_mul_i32 s87, s85, 12288
  s_add_u32 s87, s87, 2097152
  s_lshl_b32 s85, s85, 6
  s_mul_i32 s86, s69, 163840
  s_lshr_b32 s80, s3, 1
  s_and_b32 s81, s3, 1
  s_mul_i32 s82, s80, 640
  s_add_u32 s86, s86, s82
  s_mul_i32 s82, s81, 40960
  s_add_u32 s86, s86, s82
  s_mul_i32 s82, s81, 262080
  s_add_u32 s89, s85, s82
  s_mul_i32 s82, s81, 36800
  s_sub_u32 s79, s83, s82
  s_mul_i32 s82, s81, 4032
  s_sub_u32 s78, s84, s82
  s_mov_b32 s90, 0x00ff00ff
  s_mov_b32 s91, 0x00ff00ff
  s_mov_b32 s92, 0xff00ff00
  s_mov_b32 s93, 0xff00ff00
  s_mov_b32 s94, 0x3e0293ee
  s_mov_b32 s95, 0x3e0293ee
  v_mbcnt_lo_u32_b32 v32, -1, 0
  v_mbcnt_hi_u32_b32 v32, -1, v32
  v_lshlrev_b32 v0, 4, v32
  v_add_u32 v1, s83, v0
  v_lshrrev_b32 v33, 3, v32
  v_and_b32 v34, 7, v32
  v_lshlrev_b32 v12, 13, v33
  v_lshl_add_u32 v12, v34, 4, v12
  v_mul_u32_u24 v13, 1280, v33
  v_lshl_add_u32 v13, v34, 4, v13
  v_bfe_u32 v35, v32, 2, 1
  v_bfe_u32 v36, v32, 3, 1
  v_bfe_u32 v37, v32, 4, 1
  v_lshrrev_b32 v38, 5, v32
  v_and_b32 v34, 3, v32
  v_lshlrev_b32 v34, 3, v34
  v_lshl_add_u32 v8, v38, 11, v34
  v_lshl_add_u32 v8, v35, 8, v8
  v_lshl_add_u32 v8, v37, 9, v8
  v_lshl_add_u32 v8, v36, 10, v8
  v_lshl_add_u32 v10, v37, 11, v34
  v_lshl_add_u32 v10, v35, 7, v10
  v_lshl_add_u32 v10, v38, 9, v10
  v_lshl_add_u32 v10, v36, 5, v10
  v_add_u32 v9, s78, v8
  v_add_u32 v8, s79, v8
  v_add_u32 v11, s78, v10
  v_add_u32 v10, s79, v10
  v_add_u32 v14, 36864, v8
  v_add_u32 v15, 36864, v10
  v_mov_b32 v2, 0x44444444
  s_mov_b64 exec, s[92:93]
  v_mov_b32 v2, 0xeeeeeeee
  s_mov_b64 exec, -1
  v_and_b32 v33, 7, v32
  v_lshlrev_b32 v34, 4, v33
  v_lshrrev_b32 v39, 4, v32
  v_lshl_add_u32 v6, v39, 7, v34
  v_and_b32 v3, 0x30, v0
  v_lshl_add_u32 v3, v35, 2, v3
  v_lshl_add_u32 v3, v37, 6, v3
  v_lshl_add_u32 v3, v38, 3, v3
  v_lshlrev_b32 v7, 3, v33
  v_lshl_add_u32 v7, v37, 6, v7
  v_lshl_add_u32 v7, v36, 12, v7
  v_lshl_add_u32 v7, v38, 13, v7
  v_and_b32 v34, 1, v32
  v_lshlrev_b32 v34, 4, v34
  v_mov_b32 v35, 0x3f80
  v_lshlrev_b32 v34, v34, v35
  v_lshrrev_b32 v33, 1, v33
  v_lshlrev_b32 v37, 1, v37
  v_cmp_eq_u32 vcc, v33, v37
  s_nop 1
  v_cndmask_b32 v4, 0, v34, vcc
  v_add_u32 v37, 1, v37
  v_cmp_eq_u32 vcc, v33, v37
  s_nop 1
  v_cndmask_b32 v5, 0, v34, vcc
  s_lshr_b32 s76, s69, 4
  s_lshl_b32 s77, s76, 3
  s_and_b32 s82, s69, 7
  s_add_u32 s77, s77, s82
  s_add_u32 s77, s77, 32
  s_cmp_eq_u32 s3, 1
  s_cselect_b32 s77, s69, s77
  s_cmp_ge_u32 s77, 24
  s_cselect_b32 s82, 16, 0
  s_add_u32 s77, s77, s82
  s_mul_i32 s76, s76, 24
  s_add_u32 s76, s76, s69
  s_add_u32 s76, s76, 24
  s_cmp_eq_u32 s3, 0
  s_cselect_b32 s76, s76, s77
  s_bfe_u32 s81, s69, 0x10003
  s_add_u32 s81, s81, s3
  s_cmp_lt_u32 s81, 3
  s_cselect_b32 s81, 1, 0
  s_lshl_b32 s77, s76, 7
  s_add_u32 s77, s77, 327680
  s_lshl_b32 s76, s76, 12
  s_add_u32 s76, s76, 1048576
  s_cmp_eq_u32 s81, 0
  s_cbranch_scc1 CH_I2
  v_mov_b32 v32, -1
  v_mov_b32 v33, -1
  v_mov_b32 v34, -1
  v_mov_b32 v35, -1
  buffer_store_dwordx4 v[32:35], v0, s[4:7], s76 offen offset:0 sc1
  buffer_store_dwordx4 v[32:35], v0, s[4:7], s76 offen offset:1024 sc1
  buffer_store_dwordx4 v[32:35], v0, s[4:7], s76 offen offset:2048 sc1
  buffer_store_dwordx4 v[32:35], v0, s[4:7], s76 offen offset:3072 sc1
  s_add_u32 s82, s77, 0
  buffer_store_dword v32, v3, s[4:7], s82 offen sc1
  s_add_u32 s82, s77, 10240
  buffer_store_dword v32, v3, s[4:7], s82 offen sc1
  s_add_u32 s82, s77, 20480
  buffer_store_dword v32, v3, s[4:7], s82 offen sc1
  s_add_u32 s82, s77, 30720
  buffer_store_dword v32, v3, s[4:7], s82 offen sc1
CH_I2:
  s_add_u32 m0, s83, 0
  s_add_u32 s96, s89, 0
  buffer_load_dwordx4 v12, s[12:15], s96 offen lds
  s_add_u32 s96, s96, 65536
  s_add_u32 m0, m0, 1024
  s_nop 0
  buffer_load_dwordx4 v12, s[12:15], s96 offen lds
  s_add_u32 s96, s96, 65536
  s_add_u32 m0, m0, 1024
  s_nop 0
  buffer_load_dwordx4 v12, s[12:15], s96 offen lds
  s_add_u32 s96, s96, 65536
  s_add_u32 m0, m0, 1024
  s_nop 0
  buffer_load_dwordx4 v12, s[12:15], s96 offen lds
  s_add_u32 s96, s96, 65536
  s_add_u32 m0, s83, 4096
  s_add_u32 s96, s86, 81920
  buffer_load_dwordx4 v13, s[24:27], s96 offen lds
  s_add_u32 s96, s96, 10240
  s_add_u32 m0, m0, 1024
  s_nop 0
  buffer_load_dwordx4 v13, s[24:27], s96 offen lds
  s_add_u32 s96, s96, 10240
  s_add_u32 m0, m0, 1024
  s_nop 0
  buffer_load_dwordx4 v13, s[24:27], s96 offen lds
  s_add_u32 s96, s96, 10240
  s_add_u32 m0, m0, 1024
  s_nop 0
  buffer_load_dwordx4 v13, s[24:27], s96 offen lds
  s_add_u32 s96, s96, 10240
  s_add_u32 m0, s83, 8192
  s_add_u32 s96, s89, 1572864
  buffer_load_dwordx4 v12, s[16:19], s96 offen lds
  s_add_u32 s96, s96, 65536
  s_add_u32 m0, m0, 1024
  s_nop 0
  buffer_load_dwordx4 v12, s[16:19], s96 offen lds
  s_add_u32 s96, s96, 65536
  s_add_u32 m0, m0, 1024
  s_nop 0
  buffer_load_dwordx4 v12, s[16:19], s96 offen lds
  s_add_u32 s96, s96, 65536
  s_add_u32 m0, m0, 1024
  s_nop 0
  buffer_load_dwordx4 v12, s[16:19], s96 offen lds
  s_add_u32 s96, s96, 65536
  s_add_u32 m0, s83, 12288
  s_add_u32 s96, s89, 4718592
  buffer_load_dwordx4 v12, s[16:19], s96 offen lds
  s_add_u32 s96, s96, 65536
  s_add_u32 m0, m0, 1024
  s_nop 0
  buffer_load_dwordx4 v12, s[16:19], s96 offen lds
  s_add_u32 s96, s96, 65536
  s_add_u32 m0, m0, 1024
  s_nop 0
  buffer_load_dwordx4 v12, s[16:19], s96 offen lds
  s_add_u32 s96, s96, 65536
  s_add_u32 m0, m0, 1024
  s_nop 0
  buffer_load_dwordx4 v12, s[16:19], s96 offen lds
  s_add_u32 s96, s96, 65536
  s_add_u32 m0, s83, 16384
  s_add_u32 s96, s89, 0
  buffer_load_dwordx4 v12, s[16:19], s96 offen lds
  s_add_u32 s96, s96, 65536
  s_add_u32 m0, m0, 1024
  s_nop 0
  buffer_load_dwordx4 v12, s[16:19], s96 offen lds
  s_add_u32 s96, s96, 65536
  s_add_u32 m0, m0, 1024
  s_nop 0
  buffer_load_dwordx4 v12, s[16:19], s96 offen lds
  s_add_u32 s96, s96, 65536
  s_add_u32 m0, m0, 1024
  s_nop 0
  buffer_load_dwordx4 v12, s[16:19], s96 offen lds
  s_add_u32 s96, s96, 65536
  s_add_u32 m0, s83, 20480
  s_add_u32 s96, s89, 0
  buffer_load_dwordx4 v12, s[20:23], s96 offen lds
  s_add_u32 s96, s96, 65536
  s_add_u32 m0, m0, 1024
  s_nop 0
  buffer_load_dwordx4 v12, s[20:23], s96 offen lds
  s_add_u32 s96, s96, 65536
  s_add_u32 m0, m0, 1024
  s_nop 0
  buffer_load_dwordx4 v12, s[20:23], s96 offen lds
  s_add_u32 s96, s96, 65536
  s_add_u32 m0, m0, 1024
  s_nop 0
  buffer_load_dwordx4 v12, s[20:23], s96 offen lds
  s_add_u32 s96, s96, 65536
  s_add_u32 m0, s83, 24576
  s_add_u32 s96, s89, 524288
  buffer_load_dwordx4 v12, s[12:15], s96 offen lds
  s_add_u32 s96, s96, 65536
  s_add_u32 m0, m0, 1024
  s_nop 0
  buffer_load_dwordx4 v12, s[12:15], s96 offen lds
  s_add_u32 s96, s96, 65536
  s_add_u32 m0, m0, 1024
  s_nop 0
  buffer_load_dwordx4 v12, s[12:15], s96 offen lds
  s_add_u32 s96, s96, 65536
  s_add_u32 m0, m0, 1024
  s_nop 0
  buffer_load_dwordx4 v12, s[12:15], s96 offen lds
  s_add_u32 s96, s96, 65536
  s_add_u32 m0, s83, 28672
  s_add_u32 s96, s89, 524288
  buffer_load_dwordx4 v12, s[20:23], s96 offen lds
  s_add_u32 s96, s96, 65536
  s_add_u32 m0, m0, 1024
  s_nop 0
  buffer_load_dwordx4 v12, s[20:23], s96 offen lds
  s_add_u32 s96, s96, 65536
  s_add_u32 m0, m0, 1024
  s_nop 0
  buffer_load_dwordx4 v12, s[20:23], s96 offen lds
  s_add_u32 s96, s96, 65536
  s_add_u32 m0, m0, 1024
  s_nop 0
  buffer_load_dwordx4 v12, s[20:23], s96 offen lds
  s_add_u32 s96, s96, 65536
  s_add_u32 m0, s83, 32768
  s_add_u32 s96, s89, 1048576
  buffer_load_dwordx4 v12, s[12:15], s96 offen lds
  s_add_u32 s96, s96, 65536
  s_add_u32 m0, m0, 1024
  s_nop 0
  buffer_load_dwordx4 v12, s[12:15], s96 offen lds
  s_add_u32 s96, s96, 65536
  s_add_u32 m0, m0, 1024
  s_nop 0
  buffer_load_dwordx4 v12, s[12:15], s96 offen lds
  s_add_u32 s96, s96, 65536
  s_add_u32 m0, m0, 1024
  s_nop 0
  buffer_load_dwordx4 v12, s[12:15], s96 offen lds
  s_add_u32 s96, s96, 65536
  s_add_u32 m0, s84, 0
  s_add_u32 s96, s89, 1048576
  buffer_load_dwordx4 v12, s[16:19], s96 offen lds
  s_add_u32 s96, s96, 65536
  s_add_u32 m0, m0, 1024
  s_nop 0
  buffer_load_dwordx4 v12, s[16:19], s96 offen lds
  s_add_u32 s96, s96, 65536
  s_add_u32 m0, m0, 1024
  s_nop 0
  buffer_load_dwordx4 v12, s[16:19], s96 offen lds
  s_add_u32 s96, s96, 65536
  s_add_u32 m0, m0, 1024
  s_nop 0
  buffer_load_dwordx4 v12, s[16:19], s96 offen lds
  s_add_u32 s96, s96, 65536
  s_waitcnt vmcnt(36)
  s_barrier
  ds_read_b64_tr_b16 v[16:17], v8 offset:0
  ds_read_b64_tr_b16 v[18:19], v8 offset:128
  ds_read_b64_tr_b16 v[20:21], v14 offset:0
  ds_read_b64_tr_b16 v[22:23], v14 offset:128
  ds_read_b64_tr_b16 v[24:25], v8 offset:32
  ds_read_b64_tr_b16 v[26:27], v8 offset:160
  ds_read_b64_tr_b16 v[28:29], v14 offset:32
  ds_read_b64_tr_b16 v[30:31], v14 offset:160
  s_waitcnt lgkmcnt(0)
  s_barrier
  s_add_u32 s82, s87, 0
  buffer_store_dwordx4 v[16:19], v0, s[4:7], s82 offen offset:0
  buffer_store_dwordx4 v[20:23], v0, s[4:7], s82 offen offset:1024
  buffer_store_dwordx4 v[24:27], v0, s[4:7], s82 offen offset:2048
  buffer_store_dwordx4 v[28:31], v0, s[4:7], s82 offen offset:3072
  v_mov_b32 v32, 1
  s_mov_b64 exec, 1
  buffer_atomic_add v32, off, s[28:31], 0 offset:32
  s_mov_b64 exec, -1
  s_add_u32 m0, s83, 0
  s_add_u32 s96, s89, 1048576
  buffer_load_dwordx4 v12, s[20:23], s96 offen lds
  s_add_u32 s96, s96, 65536
  s_add_u32 m0, m0, 1024
  s_nop 0
  buffer_load_dwordx4 v12, s[20:23], s96 offen lds
  s_add_u32 s96, s96, 65536
  s_add_u32 m0, m0, 1024
  s_nop 0
  buffer_load_dwordx4 v12, s[20:23], s96 offen lds
  s_add_u32 s96, s96, 65536
  s_add_u32 m0, m0, 1024
  s_nop 0
  buffer_load_dwordx4 v12, s[20:23], s96 offen lds
  s_add_u32 s96, s96, 65536
  s_waitcnt vmcnt(41)
  s_barrier
  ds_read_b64_tr_b16 v[16:17], v10 offset:4096
  ds_read_b64_tr_b16 v[18:19], v10 offset:4352
  ds_read_b64_tr_b16 v[20:21], v10 offset:5120
  ds_read_b64_tr_b16 v[22:23], v10 offset:5376
  ds_read_b64_tr_b16 v[24:25], v15 offset:4096
  ds_read_b64_tr_b16 v[26:27], v15 offset:4352
  ds_read_b64_tr_b16 v[28:29], v15 offset:5120
  ds_read_b64_tr_b16 v[30:31], v15 offset:5376
  s_waitcnt lgkmcnt(0)
  s_barrier
  s_add_u32 s82, s87, 8192
  buffer_store_dwordx4 v[16:19], v0, s[4:7], s82 offen offset:0
  buffer_store_dwordx4 v[20:23], v0, s[4:7], s82 offen offset:1024
  buffer_store_dwordx4 v[24:27], v0, s[4:7], s82 offen offset:2048
  buffer_store_dwordx4 v[28:31], v0, s[4:7], s82 offen offset:3072
  s_add_u32 m0, s83, 4096
  s_add_u32 s96, s86, 128
  buffer_load_dwordx4 v13, s[24:27], s96 offen lds
  s_add_u32 s96, s96, 10240
  s_add_u32 m0, m0, 1024
  s_nop 0
  buffer_load_dwordx4 v13, s[24:27], s96 offen lds
  s_add_u32 s96, s96, 10240
  s_add_u32 m0, m0, 1024
  s_nop 0
  buffer_load_dwordx4 v13, s[24:27], s96 offen lds
  s_add_u32 s96, s96, 10240
  s_add_u32 m0, m0, 1024
  s_nop 0
  buffer_load_dwordx4 v13, s[24:27], s96 offen lds
  s_add_u32 s96, s96, 10240
  s_waitcnt vmcnt(45)
  s_barrier
  ds_read_b64_tr_b16 v[16:17], v8 offset:8192
  ds_read_b64_tr_b16 v[18:19], v8 offset:8320
  ds_read_b64_tr_b16 v[20:21], v14 offset:8192
  ds_read_b64_tr_b16 v[22:23], v14 offset:8320
  ds_read_b64_tr_b16 v[248:249], v8 offset:8224
  ds_read_b64_tr_b16 v[250:251], v8 offset:8352
  ds_read_b64_tr_b16 v[252:253], v14 offset:8224
  ds_read_b64_tr_b16 v[254:255], v14 offset:8352
  s_waitcnt lgkmcnt(0)
  s_barrier
  s_add_u32 s82, s87, 4096
  buffer_store_dwordx4 v[16:19], v0, s[4:7], s82 offen offset:0
  buffer_store_dwordx4 v[20:23], v0, s[4:7], s82 offen offset:1024
  s_add_u32 m0, s83, 8192
  s_add_u32 s96, s89, 1572864
  buffer_load_dwordx4 v12, s[20:23], s96 offen lds
  s_add_u32 s96, s96, 65536
  s_add_u32 m0, m0, 1024
  s_nop 0
  buffer_load_dwordx4 v12, s[20:23], s96 offen lds
  s_add_u32 s96, s96, 65536
  s_add_u32 m0, m0, 1024
  s_nop 0
  buffer_load_dwordx4 v12, s[20:23], s96 offen lds
  s_add_u32 s96, s96, 65536
  s_add_u32 m0, m0, 1024
  s_nop 0
  buffer_load_dwordx4 v12, s[20:23], s96 offen lds
  s_add_u32 s96, s96, 65536
  s_waitcnt vmcnt(47)
  s_barrier
  ds_read_b64_tr_b16 v[240:241], v8 offset:12288
  ds_read_b64_tr_b16 v[242:243], v8 offset:12416
  ds_read_b64_tr_b16 v[244:245], v14 offset:12288
  ds_read_b64_tr_b16 v[246:247], v14 offset:12416
  ds_read_b64_tr_b16 v[24:25], v8 offset:12320
  ds_read_b64_tr_b16 v[26:27], v8 offset:12448
  ds_read_b64_tr_b16 v[28:29], v14 offset:12320
  ds_read_b64_tr_b16 v[30:31], v14 offset:12448
  s_waitcnt lgkmcnt(0)
  s_barrier
  s_add_u32 s82, s87, 4096
  buffer_store_dwordx4 v[24:27], v0, s[4:7], s82 offen offset:2048
  buffer_store_dwordx4 v[28:31], v0, s[4:7], s82 offen offset:3072
  s_add_u32 m0, s83, 12288
  s_add_u32 s96, s89, 2097152
  buffer_load_dwordx4 v12, s[12:15], s96 offen lds
  s_add_u32 s96, s96, 65536
  s_add_u32 m0, m0, 1024
  s_nop 0
  buffer_load_dwordx4 v12, s[12:15], s96 offen lds
  s_add_u32 s96, s96, 65536
  s_add_u32 m0, m0, 1024
  s_nop 0
  buffer_load_dwordx4 v12, s[12:15], s96 offen lds
  s_add_u32 s96, s96, 65536
  s_add_u32 m0, m0, 1024
  s_nop 0
  buffer_load_dwordx4 v12, s[12:15], s96 offen lds
  s_add_u32 s96, s96, 65536
  s_waitcnt vmcnt(49)
  s_barrier
  ds_read_b64_tr_b16 a[0:1], v8 offset:16384
  ds_read_b64_tr_b16 a[2:3], v8 offset:16512
  ds_read_b64_tr_b16 a[4:5], v14 offset:16384
  ds_read_b64_tr_b16 a[6:7], v14 offset:16512
  ds_read_b64_tr_b16 a[8:9], v8 offset:16416
  ds_read_b64_tr_b16 a[10:11], v8 offset:16544
  ds_read_b64_tr_b16 a[12:13], v14 offset:16416
  ds_read_b64_tr_b16 a[14:15], v14 offset:16544
  s_waitcnt lgkmcnt(0)
  s_barrier
  s_add_u32 m0, s83, 16384
  s_add_u32 s96, s89, 2097152
  buffer_load_dwordx4 v12, s[20:23], s96 offen lds
  s_add_u32 s96, s96, 65536
  s_add_u32 m0, m0, 1024
  s_nop 0
  buffer_load_dwordx4 v12, s[20:23], s96 offen lds
  s_add_u32 s96, s96, 65536
  s_add_u32 m0, m0, 1024
  s_nop 0
  buffer_load_dwordx4 v12, s[20:23], s96 offen lds
  s_add_u32 s96, s96, 65536
  s_add_u32 m0, m0, 1024
  s_nop 0
  buffer_load_dwordx4 v12, s[20:23], s96 offen lds
  s_add_u32 s96, s96, 65536
  s_waitcnt vmcnt(49)
  s_barrier
  ds_read_b64_tr_b16 a[16:17], v8 offset:20480
  ds_read_b64_tr_b16 a[18:19], v8 offset:20608
  ds_read_b64_tr_b16 a[20:21], v14 offset:20480
  ds_read_b64_tr_b16 a[22:23], v14 offset:20608
  ds_read_b64_tr_b16 a[24:25], v8 offset:20512
  ds_read_b64_tr_b16 a[26:27], v8 offset:20640
  ds_read_b64_tr_b16 a[28:29], v14 offset:20512
  ds_read_b64_tr_b16 a[30:31], v14 offset:20640
  s_waitcnt lgkmcnt(0)
  s_barrier
  s_add_u32 m0, s83, 20480
  s_add_u32 s96, s86, 256
  buffer_load_dwordx4 v13, s[24:27], s96 offen lds
  s_add_u32 s96, s96, 10240
  s_add_u32 m0, m0, 1024
  s_nop 0
  buffer_load_dwordx4 v13, s[24:27], s96 offen lds
  s_add_u32 s96, s96, 10240
  s_add_u32 m0, m0, 1024
  s_nop 0
  buffer_load_dwordx4 v13, s[24:27], s96 offen lds
  s_add_u32 s96, s96, 10240
  s_add_u32 m0, m0, 1024
  s_nop 0
  buffer_load_dwordx4 v13, s[24:27], s96 offen lds
  s_add_u32 s96, s96, 10240
  s_waitcnt vmcnt(49)
  s_barrier
  ds_read_b64_tr_b16 a[32:33], v8 offset:24576
  ds_read_b64_tr_b16 a[34:35], v8 offset:24704
  ds_read_b64_tr_b16 a[36:37], v14 offset:24576
  ds_read_b64_tr_b16 a[38:39], v14 offset:24704
  ds_read_b64_tr_b16 a[40:41], v8 offset:24608
  ds_read_b64_tr_b16 a[42:43], v8 offset:24736
  ds_read_b64_tr_b16 a[44:45], v14 offset:24608
  ds_read_b64_tr_b16 a[46:47], v14 offset:24736
  s_waitcnt lgkmcnt(0)
  s_barrier
  s_add_u32 m0, s83, 24576
  s_add_u32 s96, s89, 2621440
  buffer_load_dwordx4 v12, s[12:15], s96 offen lds
  s_add_u32 s96, s96, 65536
  s_add_u32 m0, m0, 1024
  s_nop 0
  buffer_load_dwordx4 v12, s[12:15], s96 offen lds
  s_add_u32 s96, s96, 65536
  s_add_u32 m0, m0, 1024
  s_nop 0
  buffer_load_dwordx4 v12, s[12:15], s96 offen lds
  s_add_u32 s96, s96, 65536
  s_add_u32 m0, m0, 1024
  s_nop 0
  buffer_load_dwordx4 v12, s[12:15], s96 offen lds
  s_add_u32 s96, s96, 65536
  s_waitcnt vmcnt(49)
  s_barrier
  ds_read_b64_tr_b16 a[48:49], v8 offset:28672
  ds_read_b64_tr_b16 a[50:51], v8 offset:28800
  ds_read_b64_tr_b16 a[52:53], v14 offset:28672
  ds_read_b64_tr_b16 a[54:55], v14 offset:28800
  ds_read_b64_tr_b16 a[56:57], v8 offset:28704
  ds_read_b64_tr_b16 a[58:59], v8 offset:28832
  ds_read_b64_tr_b16 a[60:61], v14 offset:28704
  ds_read_b64_tr_b16 a[62:63], v14 offset:28832
  s_waitcnt lgkmcnt(0)
  s_barrier
  s_add_u32 m0, s83, 28672
  s_add_u32 s96, s89, 2621440
  buffer_load_dwordx4 v12, s[16:19], s96 offen lds
  s_add_u32 s96, s96, 65536
  s_add_u32 m0, m0, 1024
  s_nop 0
  buffer_load_dwordx4 v12, s[16:19], s96 offen lds
  s_add_u32 s96, s96, 65536
  s_add_u32 m0, m0, 1024
  s_nop 0
  buffer_load_dwordx4 v12, s[16:19], s96 offen lds
  s_add_u32 s96, s96, 65536
  s_add_u32 m0, m0, 1024
  s_nop 0
  buffer_load_dwordx4 v12, s[16:19], s96 offen lds
  s_add_u32 s96, s96, 65536
  s_waitcnt vmcnt(49)
  s_barrier
  ds_read_b64_tr_b16 a[64:65], v8 offset:32768
  ds_read_b64_tr_b16 a[66:67], v8 offset:32896
  ds_read_b64_tr_b16 a[68:69], v14 offset:32768
  ds_read_b64_tr_b16 a[70:71], v14 offset:32896
  ds_read_b64_tr_b16 a[72:73], v8 offset:32800
  ds_read_b64_tr_b16 a[74:75], v8 offset:32928
  ds_read_b64_tr_b16 a[76:77], v14 offset:32800
  ds_read_b64_tr_b16 a[78:79], v14 offset:32928
  s_waitcnt lgkmcnt(0)
  s_barrier
  s_add_u32 m0, s83, 32768
  s_add_u32 s96, s89, 2621440
  buffer_load_dwordx4 v12, s[20:23], s96 offen lds
  s_add_u32 s96, s96, 65536
  s_add_u32 m0, m0, 1024
  s_nop 0
  buffer_load_dwordx4 v12, s[20:23], s96 offen lds
  s_add_u32 s96, s96, 65536
  s_add_u32 m0, m0, 1024
  s_nop 0
  buffer_load_dwordx4 v12, s[20:23], s96 offen lds
  s_add_u32 s96, s96, 65536
  s_add_u32 m0, m0, 1024
  s_nop 0
  buffer_load_dwordx4 v12, s[20:23], s96 offen lds
  s_add_u32 s96, s96, 65536
  s_waitcnt vmcnt(49)
  s_barrier
  ds_read_b64_tr_b16 a[80:81], v9 offset:0
  ds_read_b64_tr_b16 a[82:83], v9 offset:128
  ds_read_b64_tr_b16 a[84:85], v9 offset:4096
  ds_read_b64_tr_b16 a[86:87], v9 offset:4224
  ds_read_b64_tr_b16 a[88:89], v9 offset:32
  ds_read_b64_tr_b16 a[90:91], v9 offset:160
  ds_read_b64_tr_b16 a[92:93], v9 offset:4128
  ds_read_b64_tr_b16 a[94:95], v9 offset:4256
  s_waitcnt lgkmcnt(0)
  s_barrier
  s_add_u32 m0, s84, 0
  s_add_u32 s96, s86, 82176
  buffer_load_dwordx4 v13, s[24:27], s96 offen lds
  s_add_u32 s96, s96, 10240
  s_add_u32 m0, m0, 1024
  s_nop 0
  buffer_load_dwordx4 v13, s[24:27], s96 offen lds
  s_add_u32 s96, s96, 10240
  s_add_u32 m0, m0, 1024
  s_nop 0
  buffer_load_dwordx4 v13, s[24:27], s96 offen lds
  s_add_u32 s96, s96, 10240
  s_add_u32 m0, m0, 1024
  s_nop 0
  buffer_load_dwordx4 v13, s[24:27], s96 offen lds
  s_add_u32 s96, s96, 10240
  s_waitcnt vmcnt(44)
  s_barrier
  ds_read_b64_tr_b16 a[96:97], v8 offset:0
  ds_read_b64_tr_b16 a[98:99], v8 offset:128
  ds_read_b64_tr_b16 a[100:101], v14 offset:0
  ds_read_b64_tr_b16 a[102:103], v14 offset:128
  ds_read_b64_tr_b16 a[104:105], v8 offset:32
  ds_read_b64_tr_b16 a[106:107], v8 offset:160
  ds_read_b64_tr_b16 a[108:109], v14 offset:32
  ds_read_b64_tr_b16 a[110:111], v14 offset:160
  s_waitcnt lgkmcnt(0)
  s_barrier
  s_add_u32 m0, s83, 0
  s_add_u32 s96, s89, 3145728
  buffer_load_dwordx4 v12, s[16:19], s96 offen lds
  s_add_u32 s96, s96, 65536
  s_add_u32 m0, m0, 1024
  s_nop 0
  buffer_load_dwordx4 v12, s[16:19], s96 offen lds
  s_add_u32 s96, s96, 65536
  s_add_u32 m0, m0, 1024
  s_nop 0
  buffer_load_dwordx4 v12, s[16:19], s96 offen lds
  s_add_u32 s96, s96, 65536
  s_add_u32 m0, m0, 1024
  s_nop 0
  buffer_load_dwordx4 v12, s[16:19], s96 offen lds
  s_add_u32 s96, s96, 65536
  s_waitcnt vmcnt(40)
  s_barrier
  ds_read_b64_tr_b16 a[112:113], v10 offset:4096
  ds_read_b64_tr_b16 a[114:115], v10 offset:4352
  ds_read_b64_tr_b16 a[116:117], v10 offset:5120
  ds_read_b64_tr_b16 a[118:119], v10 offset:5376
  ds_read_b64_tr_b16 a[120:121], v15 offset:4096
  ds_read_b64_tr_b16 a[122:123], v15 offset:4352
  ds_read_b64_tr_b16 a[124:125], v15 offset:5120
  ds_read_b64_tr_b16 a[126:127], v15 offset:5376
  s_waitcnt lgkmcnt(0)
  s_barrier
  s_add_u32 m0, s83, 4096
  s_add_u32 s96, s89, 3145728
  buffer_load_dwordx4 v12, s[20:23], s96 offen lds
  s_add_u32 s96, s96, 65536
  s_add_u32 m0, m0, 1024
  s_nop 0
  buffer_load_dwordx4 v12, s[20:23], s96 offen lds
  s_add_u32 s96, s96, 65536
  s_add_u32 m0, m0, 1024
  s_nop 0
  buffer_load_dwordx4 v12, s[20:23], s96 offen lds
  s_add_u32 s96, s96, 65536
  s_add_u32 m0, m0, 1024
  s_nop 0
  buffer_load_dwordx4 v12, s[20:23], s96 offen lds
  s_add_u32 s96, s96, 65536
  s_waitcnt vmcnt(38)
  s_barrier
  ds_read_b64_tr_b16 a[128:129], v8 offset:8192
  ds_read_b64_tr_b16 a[130:131], v8 offset:8320
  ds_read_b64_tr_b16 a[132:133], v14 offset:8192
  ds_read_b64_tr_b16 a[134:135], v14 offset:8320
  ds_read_b64_tr_b16 a[136:137], v8 offset:8224
  ds_read_b64_tr_b16 a[138:139], v8 offset:8352
  ds_read_b64_tr_b16 a[140:141], v14 offset:8224
  ds_read_b64_tr_b16 a[142:143], v14 offset:8352
  s_waitcnt lgkmcnt(0)
  s_barrier
  s_add_u32 m0, s83, 8192
  s_add_u32 s96, s89, 3670016
  buffer_load_dwordx4 v12, s[12:15], s96 offen lds
  s_add_u32 s96, s96, 65536
  s_add_u32 m0, m0, 1024
  s_nop 0
  buffer_load_dwordx4 v12, s[12:15], s96 offen lds
  s_add_u32 s96, s96, 65536
  s_add_u32 m0, m0, 1024
  s_nop 0
  buffer_load_dwordx4 v12, s[12:15], s96 offen lds
  s_add_u32 s96, s96, 65536
  s_add_u32 m0, m0, 1024
  s_nop 0
  buffer_load_dwordx4 v12, s[12:15], s96 offen lds
  s_add_u32 s96, s96, 65536
  s_waitcnt vmcnt(36)
  s_barrier
  ds_read_b64_tr_b16 a[144:145], v8 offset:12288
  ds_read_b64_tr_b16 a[146:147], v8 offset:12416
  ds_read_b64_tr_b16 a[148:149], v14 offset:12288
  ds_read_b64_tr_b16 a[150:151], v14 offset:12416
  ds_read_b64_tr_b16 a[152:153], v8 offset:12320
  ds_read_b64_tr_b16 a[154:155], v8 offset:12448
  ds_read_b64_tr_b16 a[156:157], v14 offset:12320
  ds_read_b64_tr_b16 a[158:159], v14 offset:12448
  s_waitcnt lgkmcnt(0)
  s_barrier
  s_add_u32 m0, s83, 12288
  s_add_u32 s96, s89, 3670016
  buffer_load_dwordx4 v12, s[20:23], s96 offen lds
  s_add_u32 s96, s96, 65536
  s_add_u32 m0, m0, 1024
  s_nop 0
  buffer_load_dwordx4 v12, s[20:23], s96 offen lds
  s_add_u32 s96, s96, 65536
  s_add_u32 m0, m0, 1024
  s_nop 0
  buffer_load_dwordx4 v12, s[20:23], s96 offen lds
  s_add_u32 s96, s96, 65536
  s_add_u32 m0, m0, 1024
  s_nop 0
  buffer_load_dwordx4 v12, s[20:23], s96 offen lds
  s_add_u32 s96, s96, 65536
  s_waitcnt vmcnt(36)
  s_barrier
  ds_read_b64_tr_b16 a[160:161], v8 offset:16384
  ds_read_b64_tr_b16 a[162:163], v8 offset:16512
  ds_read_b64_tr_b16 a[164:165], v14 offset:16384
  ds_read_b64_tr_b16 a[166:167], v14 offset:16512
  ds_read_b64_tr_b16 a[168:169], v8 offset:16416
  ds_read_b64_tr_b16 a[170:171], v8 offset:16544
  ds_read_b64_tr_b16 a[172:173], v14 offset:16416
  ds_read_b64_tr_b16 a[174:175], v14 offset:16544
  s_waitcnt lgkmcnt(0)
  s_barrier
  s_add_u32 m0, s83, 16384
  s_add_u32 s96, s86, 82304
  buffer_load_dwordx4 v13, s[24:27], s96 offen lds
  s_add_u32 s96, s96, 10240
  s_add_u32 m0, m0, 1024
  s_nop 0
  buffer_load_dwordx4 v13, s[24:27], s96 offen lds
  s_add_u32 s96, s96, 10240
  s_add_u32 m0, m0, 1024
  s_nop 0
  buffer_load_dwordx4 v13, s[24:27], s96 offen lds
  s_add_u32 s96, s96, 10240
  s_add_u32 m0, m0, 1024
  s_nop 0
  buffer_load_dwordx4 v13, s[24:27], s96 offen lds
  s_add_u32 s96, s96, 10240
  s_waitcnt vmcnt(36)
  s_barrier
  ds_read_b64_tr_b16 a[176:177], v10 offset:20480
  ds_read_b64_tr_b16 a[178:179], v10 offset:20736
  ds_read_b64_tr_b16 a[180:181], v10 offset:21504
  ds_read_b64_tr_b16 a[182:183], v10 offset:21760
  ds_read_b64_tr_b16 a[184:185], v15 offset:20480
  ds_read_b64_tr_b16 a[186:187], v15 offset:20736
  ds_read_b64_tr_b16 a[188:189], v15 offset:21504
  ds_read_b64_tr_b16 a[190:191], v15 offset:21760
  s_waitcnt lgkmcnt(0)
  s_barrier
  s_add_u32 m0, s83, 20480
  s_add_u32 s96, s89, 4194304
  buffer_load_dwordx4 v12, s[12:15], s96 offen lds
  s_add_u32 s96, s96, 65536
  s_add_u32 m0, m0, 1024
  s_nop 0
  buffer_load_dwordx4 v12, s[12:15], s96 offen lds
  s_add_u32 s96, s96, 65536
  s_add_u32 m0, m0, 1024
  s_nop 0
  buffer_load_dwordx4 v12, s[12:15], s96 offen lds
  s_add_u32 s96, s96, 65536
  s_add_u32 m0, m0, 1024
  s_nop 0
  buffer_load_dwordx4 v12, s[12:15], s96 offen lds
  s_add_u32 s96, s96, 65536
  s_waitcnt vmcnt(36)
  s_barrier
  ds_read_b64_tr_b16 a[192:193], v8 offset:24576
  ds_read_b64_tr_b16 a[194:195], v8 offset:24704
  ds_read_b64_tr_b16 a[196:197], v14 offset:24576
  ds_read_b64_tr_b16 a[198:199], v14 offset:24704
  ds_read_b64_tr_b16 a[200:201], v8 offset:24608
  ds_read_b64_tr_b16 a[202:203], v8 offset:24736
  ds_read_b64_tr_b16 a[204:205], v14 offset:24608
  ds_read_b64_tr_b16 a[206:207], v14 offset:24736
  s_waitcnt lgkmcnt(0)
  s_barrier
  s_add_u32 m0, s83, 24576
  s_add_u32 s96, s89, 4194304
  buffer_load_dwordx4 v12, s[16:19], s96 offen lds
  s_add_u32 s96, s96, 65536
  s_add_u32 m0, m0, 1024
  s_nop 0
  buffer_load_dwordx4 v12, s[16:19], s96 offen lds
  s_add_u32 s96, s96, 65536
  s_add_u32 m0, m0, 1024
  s_nop 0
  buffer_load_dwordx4 v12, s[16:19], s96 offen lds
  s_add_u32 s96, s96, 65536
  s_add_u32 m0, m0, 1024
  s_nop 0
  buffer_load_dwordx4 v12, s[16:19], s96 offen lds
  s_add_u32 s96, s96, 65536
  s_waitcnt vmcnt(36)
  s_barrier
  ds_read_b64_tr_b16 a[208:209], v8 offset:28672
  ds_read_b64_tr_b16 a[210:211], v8 offset:28800
  ds_read_b64_tr_b16 a[212:213], v14 offset:28672
  ds_read_b64_tr_b16 a[214:215], v14 offset:28800
  ds_read_b64_tr_b16 a[216:217], v8 offset:28704
  ds_read_b64_tr_b16 a[218:219], v8 offset:28832
  ds_read_b64_tr_b16 a[220:221], v14 offset:28704
  ds_read_b64_tr_b16 a[222:223], v14 offset:28832
  s_waitcnt lgkmcnt(0)
  s_barrier
  s_add_u32 m0, s83, 28672
  s_add_u32 s96, s89, 4194304
  buffer_load_dwordx4 v12, s[20:23], s96 offen lds
  s_add_u32 s96, s96, 65536
  s_add_u32 m0, m0, 1024
  s_nop 0
  buffer_load_dwordx4 v12, s[20:23], s96 offen lds
  s_add_u32 s96, s96, 65536
  s_add_u32 m0, m0, 1024
  s_nop 0
  buffer_load_dwordx4 v12, s[20:23], s96 offen lds
  s_add_u32 s96, s96, 65536
  s_add_u32 m0, m0, 1024
  s_nop 0
  buffer_load_dwordx4 v12, s[20:23], s96 offen lds
  s_add_u32 s96, s96, 65536
  s_waitcnt vmcnt(36)
  s_barrier
  ds_read_b64_tr_b16 a[224:225], v8 offset:32768
  ds_read_b64_tr_b16 a[226:227], v8 offset:32896
  ds_read_b64_tr_b16 a[228:229], v14 offset:32768
  ds_read_b64_tr_b16 a[230:231], v14 offset:32896
  ds_read_b64_tr_b16 a[232:233], v8 offset:32800
  ds_read_b64_tr_b16 a[234:235], v8 offset:32928
  ds_read_b64_tr_b16 a[236:237], v14 offset:32800
  ds_read_b64_tr_b16 a[238:239], v14 offset:32928
  s_waitcnt lgkmcnt(0)
  s_barrier
  s_add_u32 m0, s83, 32768
  s_add_u32 s96, s86, 512
  buffer_load_dwordx4 v13, s[24:27], s96 offen lds
  s_add_u32 s96, s96, 10240
  s_add_u32 m0, m0, 1024
  s_nop 0
  buffer_load_dwordx4 v13, s[24:27], s96 offen lds
  s_add_u32 s96, s96, 10240
  s_add_u32 m0, m0, 1024
  s_nop 0
  buffer_load_dwordx4 v13, s[24:27], s96 offen lds
  s_add_u32 s96, s96, 10240
  s_add_u32 m0, m0, 1024
  s_nop 0
  buffer_load_dwordx4 v13, s[24:27], s96 offen lds
  s_add_u32 s96, s96, 10240
  s_waitcnt vmcnt(36)
  s_barrier
  ds_read_b64_tr_b16 a[240:241], v11 offset:0
  ds_read_b64_tr_b16 a[242:243], v11 offset:256
  ds_read_b64_tr_b16 a[244:245], v11 offset:1024
  ds_read_b64_tr_b16 a[246:247], v11 offset:1280
  ds_read_b64_tr_b16 a[248:249], v11 offset:4096
  ds_read_b64_tr_b16 a[250:251], v11 offset:4352
  ds_read_b64_tr_b16 a[252:253], v11 offset:5120
  ds_read_b64_tr_b16 a[254:255], v11 offset:5376
  s_waitcnt lgkmcnt(0)
  s_barrier
  s_add_u32 m0, s84, 0
  s_add_u32 s96, s89, 4718592
  buffer_load_dwordx4 v12, s[12:15], s96 offen lds
  s_add_u32 s96, s96, 65536
  s_add_u32 m0, m0, 1024
  s_nop 0
  buffer_load_dwordx4 v12, s[12:15], s96 offen lds
  s_add_u32 s96, s96, 65536
  s_add_u32 m0, m0, 1024
  s_nop 0
  buffer_load_dwordx4 v12, s[12:15], s96 offen lds
  s_add_u32 s96, s96, 65536
  s_add_u32 m0, m0, 1024
  s_nop 0
  buffer_load_dwordx4 v12, s[12:15], s96 offen lds
  s_add_u32 s96, s96, 65536
  s_waitcnt vmcnt(36)
  s_barrier
  ds_read_b64_tr_b16 v[64:65], v8 offset:0
  ds_read_b64_tr_b16 v[66:67], v8 offset:128
  ds_read_b64_tr_b16 v[68:69], v14 offset:0
  ds_read_b64_tr_b16 v[70:71], v14 offset:128
  ds_read_b64_tr_b16 v[72:73], v8 offset:32
  ds_read_b64_tr_b16 v[74:75], v8 offset:160
  ds_read_b64_tr_b16 v[76:77], v14 offset:32
  ds_read_b64_tr_b16 v[78:79], v14 offset:160
  s_waitcnt lgkmcnt(0)
  s_barrier
  v_mbcnt_lo_u32_b32 v42, -1, 0
  v_mbcnt_hi_u32_b32 v42, -1, v42
  v_lshlrev_b32 v42, 2, v42
  buffer_load_dword v43, v42, s[28:31], 0 offen sc1
  s_add_u32 m0, s83, 0
  s_add_u32 s96, s89, 524288
  buffer_load_dwordx4 v12, s[16:19], s96 offen lds
  s_add_u32 s96, s96, 65536
  s_add_u32 m0, m0, 1024
  s_nop 0
  buffer_load_dwordx4 v12, s[16:19], s96 offen lds
  s_add_u32 s96, s96, 65536
  s_add_u32 m0, m0, 1024
  s_nop 0
  buffer_load_dwordx4 v12, s[16:19], s96 offen lds
  s_add_u32 s96, s96, 65536
  s_add_u32 m0, m0, 1024
  s_nop 0
  buffer_load_dwordx4 v12, s[16:19], s96 offen lds
  s_add_u32 s96, s96, 65536
  s_waitcnt vmcnt(37)
  s_barrier
  ds_read_b64_tr_b16 v[80:81], v8 offset:4096
  ds_read_b64_tr_b16 v[82:83], v8 offset:4224
  ds_read_b64_tr_b16 v[84:85], v14 offset:4096
  ds_read_b64_tr_b16 v[86:87], v14 offset:4224
  ds_read_b64_tr_b16 v[88:89], v8 offset:4128
  ds_read_b64_tr_b16 v[90:91], v8 offset:4256
  ds_read_b64_tr_b16 v[92:93], v14 offset:4128
  ds_read_b64_tr_b16 v[94:95], v14 offset:4256
  s_waitcnt lgkmcnt(0)
  s_barrier
  s_add_u32 m0, s83, 4096
  s_add_u32 s96, s89, 1572864
  buffer_load_dwordx4 v12, s[12:15], s96 offen lds
  s_add_u32 s96, s96, 65536
  s_add_u32 m0, m0, 1024
  s_nop 0
  buffer_load_dwordx4 v12, s[12:15], s96 offen lds
  s_add_u32 s96, s96, 65536
  s_add_u32 m0, m0, 1024
  s_nop 0
  buffer_load_dwordx4 v12, s[12:15], s96 offen lds
  s_add_u32 s96, s96, 65536
  s_add_u32 m0, m0, 1024
  s_nop 0
  buffer_load_dwordx4 v12, s[12:15], s96 offen lds
  s_add_u32 s96, s96, 65536
  s_waitcnt vmcnt(37)
  s_barrier
  ds_read_b64_tr_b16 v[96:97], v8 offset:8192
  ds_read_b64_tr_b16 v[98:99], v8 offset:8320
  ds_read_b64_tr_b16 v[100:101], v14 offset:8192
  ds_read_b64_tr_b16 v[102:103], v14 offset:8320
  ds_read_b64_tr_b16 v[104:105], v8 offset:8224
  ds_read_b64_tr_b16 v[106:107], v8 offset:8352
  ds_read_b64_tr_b16 v[108:109], v14 offset:8224
  ds_read_b64_tr_b16 v[110:111], v14 offset:8352
  s_waitcnt lgkmcnt(0)
  s_barrier
  s_add_u32 m0, s83, 8192
  s_add_u32 s96, s89, 2097152
  buffer_load_dwordx4 v12, s[16:19], s96 offen lds
  s_add_u32 s96, s96, 65536
  s_add_u32 m0, m0, 1024
  s_nop 0
  buffer_load_dwordx4 v12, s[16:19], s96 offen lds
  s_add_u32 s96, s96, 65536
  s_add_u32 m0, m0, 1024
  s_nop 0
  buffer_load_dwordx4 v12, s[16:19], s96 offen lds
  s_add_u32 s96, s96, 65536
  s_add_u32 m0, m0, 1024
  s_nop 0
  buffer_load_dwordx4 v12, s[16:19], s96 offen lds
  s_add_u32 s96, s96, 65536
  s_waitcnt vmcnt(37)
  s_barrier
  ds_read_b64_tr_b16 v[112:113], v8 offset:12288
  ds_read_b64_tr_b16 v[114:115], v8 offset:12416
  ds_read_b64_tr_b16 v[116:117], v14 offset:12288
  ds_read_b64_tr_b16 v[118:119], v14 offset:12416
  ds_read_b64_tr_b16 v[120:121], v8 offset:12320
  ds_read_b64_tr_b16 v[122:123], v8 offset:12448
  ds_read_b64_tr_b16 v[124:125], v14 offset:12320
  ds_read_b64_tr_b16 v[126:127], v14 offset:12448
  s_waitcnt lgkmcnt(0)
  s_barrier
  s_add_u32 m0, s83, 12288
  s_add_u32 s96, s89, 3145728
  buffer_load_dwordx4 v12, s[12:15], s96 offen lds
  s_add_u32 s96, s96, 65536
  s_add_u32 m0, m0, 1024
  s_nop 0
  buffer_load_dwordx4 v12, s[12:15], s96 offen lds
  s_add_u32 s96, s96, 65536
  s_add_u32 m0, m0, 1024
  s_nop 0
  buffer_load_dwordx4 v12, s[12:15], s96 offen lds
  s_add_u32 s96, s96, 65536
  s_add_u32 m0, m0, 1024
  s_nop 0
  buffer_load_dwordx4 v12, s[12:15], s96 offen lds
  s_add_u32 s96, s96, 65536
  s_waitcnt vmcnt(37)
  s_barrier
  ds_read_b64_tr_b16 v[128:129], v10 offset:16384
  ds_read_b64_tr_b16 v[130:131], v10 offset:16640
  ds_read_b64_tr_b16 v[132:133], v10 offset:17408
  ds_read_b64_tr_b16 v[134:135], v10 offset:17664
  ds_read_b64_tr_b16 v[136:137], v15 offset:16384
  ds_read_b64_tr_b16 v[138:139], v15 offset:16640
  ds_read_b64_tr_b16 v[140:141], v15 offset:17408
  ds_read_b64_tr_b16 v[142:143], v15 offset:17664
  s_waitcnt lgkmcnt(0)
  s_barrier
  s_add_u32 m0, s83, 16384
  s_add_u32 s96, s89, 3670016
  buffer_load_dwordx4 v12, s[16:19], s96 offen lds
  s_add_u32 s96, s96, 65536
  s_add_u32 m0, m0, 1024
  s_nop 0
  buffer_load_dwordx4 v12, s[16:19], s96 offen lds
  s_add_u32 s96, s96, 65536
  s_add_u32 m0, m0, 1024
  s_nop 0
  buffer_load_dwordx4 v12, s[16:19], s96 offen lds
  s_add_u32 s96, s96, 65536
  s_add_u32 m0, m0, 1024
  s_nop 0
  buffer_load_dwordx4 v12, s[16:19], s96 offen lds
  s_add_u32 s96, s96, 65536
  s_waitcnt vmcnt(37)
  s_barrier
  ds_read_b64_tr_b16 v[144:145], v8 offset:20480
  ds_read_b64_tr_b16 v[146:147], v8 offset:20608
  ds_read_b64_tr_b16 v[148:149], v14 offset:20480
  ds_read_b64_tr_b16 v[150:151], v14 offset:20608
  ds_read_b64_tr_b16 v[152:153], v8 offset:20512
  ds_read_b64_tr_b16 v[154:155], v8 offset:20640
  ds_read_b64_tr_b16 v[156:157], v14 offset:20512
  ds_read_b64_tr_b16 v[158:159], v14 offset:20640
  s_waitcnt lgkmcnt(0)
  s_barrier
  s_add_u32 m0, s83, 20480
  s_add_u32 s96, s86, 0
  buffer_load_dwordx4 v13, s[24:27], s96 offen lds
  s_add_u32 s96, s96, 10240
  s_add_u32 m0, m0, 1024
  s_nop 0
  buffer_load_dwordx4 v13, s[24:27], s96 offen lds
  s_add_u32 s96, s96, 10240
  s_add_u32 m0, m0, 1024
  s_nop 0
  buffer_load_dwordx4 v13, s[24:27], s96 offen lds
  s_add_u32 s96, s96, 10240
  s_add_u32 m0, m0, 1024
  s_nop 0
  buffer_load_dwordx4 v13, s[24:27], s96 offen lds
  s_add_u32 s96, s96, 10240
  s_waitcnt vmcnt(37)
  s_barrier
  ds_read_b64_tr_b16 v[160:161], v8 offset:24576
  ds_read_b64_tr_b16 v[162:163], v8 offset:24704
  ds_read_b64_tr_b16 v[164:165], v14 offset:24576
  ds_read_b64_tr_b16 v[166:167], v14 offset:24704
  ds_read_b64_tr_b16 v[168:169], v8 offset:24608
  ds_read_b64_tr_b16 v[170:171], v8 offset:24736
  ds_read_b64_tr_b16 v[172:173], v14 offset:24608
  ds_read_b64_tr_b16 v[174:175], v14 offset:24736
  s_waitcnt lgkmcnt(0)
  s_barrier
  s_add_u32 m0, s83, 24576
  s_add_u32 s96, s86, 82048
  buffer_load_dwordx4 v13, s[24:27], s96 offen lds
  s_add_u32 s96, s96, 10240
  s_add_u32 m0, m0, 1024
  s_nop 0
  buffer_load_dwordx4 v13, s[24:27], s96 offen lds
  s_add_u32 s96, s96, 10240
  s_add_u32 m0, m0, 1024
  s_nop 0
  buffer_load_dwordx4 v13, s[24:27], s96 offen lds
  s_add_u32 s96, s96, 10240
  s_add_u32 m0, m0, 1024
  s_nop 0
  buffer_load_dwordx4 v13, s[24:27], s96 offen lds
  s_add_u32 s96, s96, 10240
  s_waitcnt vmcnt(37)
  s_barrier
  ds_read_b64_tr_b16 v[176:177], v8 offset:28672
  ds_read_b64_tr_b16 v[178:179], v8 offset:28800
  ds_read_b64_tr_b16 v[180:181], v14 offset:28672
  ds_read_b64_tr_b16 v[182:183], v14 offset:28800
  ds_read_b64_tr_b16 v[184:185], v8 offset:28704
  ds_read_b64_tr_b16 v[186:187], v8 offset:28832
  ds_read_b64_tr_b16 v[188:189], v14 offset:28704
  ds_read_b64_tr_b16 v[190:191], v14 offset:28832
  s_waitcnt lgkmcnt(0)
  s_barrier
  s_add_u32 m0, s83, 28672
  s_add_u32 s96, s86, 384
  buffer_load_dwordx4 v13, s[24:27], s96 offen lds
  s_add_u32 s96, s96, 10240
  s_add_u32 m0, m0, 1024
  s_nop 0
  buffer_load_dwordx4 v13, s[24:27], s96 offen lds
  s_add_u32 s96, s96, 10240
  s_add_u32 m0, m0, 1024
  s_nop 0
  buffer_load_dwordx4 v13, s[24:27], s96 offen lds
  s_add_u32 s96, s96, 10240
  s_add_u32 m0, m0, 1024
  s_nop 0
  buffer_load_dwordx4 v13, s[24:27], s96 offen lds
  s_add_u32 s96, s96, 10240
  s_waitcnt vmcnt(37)
  s_barrier
  ds_read_b64_tr_b16 v[192:193], v10 offset:32768
  ds_read_b64_tr_b16 v[194:195], v10 offset:33024
  ds_read_b64_tr_b16 v[196:197], v10 offset:33792
  ds_read_b64_tr_b16 v[198:199], v10 offset:34048
  ds_read_b64_tr_b16 v[200:201], v15 offset:32768
  ds_read_b64_tr_b16 v[202:203], v15 offset:33024
  ds_read_b64_tr_b16 v[204:205], v15 offset:33792
  ds_read_b64_tr_b16 v[206:207], v15 offset:34048
  s_waitcnt lgkmcnt(0)
  s_barrier
  s_add_u32 m0, s83, 32768
  s_add_u32 s96, s86, 82432
  buffer_load_dwordx4 v13, s[24:27], s96 offen lds
  s_add_u32 s96, s96, 10240
  s_add_u32 m0, m0, 1024
  s_nop 0
  buffer_load_dwordx4 v13, s[24:27], s96 offen lds
  s_add_u32 s96, s96, 10240
  s_add_u32 m0, m0, 1024
  s_nop 0
  buffer_load_dwordx4 v13, s[24:27], s96 offen lds
  s_add_u32 s96, s96, 10240
  s_add_u32 m0, m0, 1024
  s_nop 0
  buffer_load_dwordx4 v13, s[24:27], s96 offen lds
  s_add_u32 s96, s96, 10240
  s_waitcnt vmcnt(37)
  s_barrier
  ds_read_b64_tr_b16 v[208:209], v9 offset:0
  ds_read_b64_tr_b16 v[210:211], v9 offset:128
  ds_read_b64_tr_b16 v[212:213], v9 offset:4096
  ds_read_b64_tr_b16 v[214:215], v9 offset:4224
  ds_read_b64_tr_b16 v[216:217], v9 offset:32
  ds_read_b64_tr_b16 v[218:219], v9 offset:160
  ds_read_b64_tr_b16 v[220:221], v9 offset:4128
  ds_read_b64_tr_b16 v[222:223], v9 offset:4256
  s_waitcnt lgkmcnt(0)
  s_barrier
  s_add_u32 m0, s84, 0
  s_add_u32 s96, s89, 4718592
  buffer_load_dwordx4 v12, s[20:23], s96 offen lds
  s_add_u32 s96, s96, 65536
  s_add_u32 m0, m0, 1024
  s_nop 0
  buffer_load_dwordx4 v12, s[20:23], s96 offen lds
  s_add_u32 s96, s96, 65536
  s_add_u32 m0, m0, 1024
  s_nop 0
  buffer_load_dwordx4 v12, s[20:23], s96 offen lds
  s_add_u32 s96, s96, 65536
  s_add_u32 m0, m0, 1024
  s_nop 0
  buffer_load_dwordx4 v12, s[20:23], s96 offen lds
  s_add_u32 s96, s96, 65536
  s_waitcnt vmcnt(36)
  s_barrier
  ds_read_b64_tr_b16 v[16:17], v8 offset:0
  ds_read_b64_tr_b16 v[18:19], v8 offset:128
  ds_read_b64_tr_b16 v[20:21], v14 offset:0
  ds_read_b64_tr_b16 v[22:23], v14 offset:128
  ds_read_b64_tr_b16 v[24:25], v8 offset:32
  ds_read_b64_tr_b16 v[26:27], v8 offset:160
  ds_read_b64_tr_b16 v[28:29], v14 offset:32
  ds_read_b64_tr_b16 v[30:31], v14 offset:160
  s_waitcnt lgkmcnt(0)
  s_barrier
  ds_write_b128 v1, v[16:19] offset:0
  ds_write_b128 v1, v[20:23] offset:1024
  ds_write_b128 v1, v[24:27] offset:2048
  ds_write_b128 v1, v[28:31] offset:3072
  s_branch L_11x
L_11:
  buffer_load_dword v43, v42, s[28:31], 0 offen sc1
  s_waitcnt vmcnt(0)
L_11x:
  v_readlane_b32 s72, v43, 0
  v_readlane_b32 s73, v43, 1
  v_readlane_b32 s74, v43, 2
  v_readlane_b32 s75, v43, 3
  v_readlane_b32 s76, v43, 4
  v_readlane_b32 s77, v43, 5
  v_readlane_b32 s78, v43, 6
  v_readlane_b32 s79, v43, 7
  v_readlane_b32 s80, v43, 8
  s_mov_b32 s81, 0
  s_mov_b32 s69, s71
  s_lshr_b32 s72, s72, 16
  s_add_u32 s81, s81, s72
  s_cmp_gt_u32 s70, 0
  s_cselect_b32 s82, s72, 0
  s_add_u32 s69, s69, s82
  s_lshr_b32 s73, s73, 16
  s_add_u32 s81, s81, s73
  s_cmp_gt_u32 s70, 1
  s_cselect_b32 s82, s73, 0
  s_add_u32 s69, s69, s82
  s_lshr_b32 s74, s74, 16
  s_add_u32 s81, s81, s74
  s_cmp_gt_u32 s70, 2
  s_cselect_b32 s82, s74, 0
  s_add_u32 s69, s69, s82
  s_lshr_b32 s75, s75, 16
  s_add_u32 s81, s81, s75
  s_cmp_gt_u32 s70, 3
  s_cselect_b32 s82, s75, 0
  s_add_u32 s69, s69, s82
  s_lshr_b32 s76, s76, 16
  s_add_u32 s81, s81, s76
  s_cmp_gt_u32 s70, 4
  s_cselect_b32 s82, s76, 0
  s_add_u32 s69, s69, s82
  s_lshr_b32 s77, s77, 16
  s_add_u32 s81, s81, s77
  s_cmp_gt_u32 s70, 5
  s_cselect_b32 s82, s77, 0
  s_add_u32 s69, s69, s82
  s_lshr_b32 s78, s78, 16
  s_add_u32 s81, s81, s78
  s_cmp_gt_u32 s70, 6
  s_cselect_b32 s82, s78, 0
  s_add_u32 s69, s69, s82
  s_lshr_b32 s79, s79, 16
  s_add_u32 s81, s81, s79
  s_cmp_gt_u32 s70, 7
  s_cselect_b32 s82, s79, 0
  s_add_u32 s69, s69, s82
  s_cmp_ge_u32 s80, 128
  s_cselect_b32 s81, s81, 0
  s_cmp_ge_u32 s81, 256
  s_cbranch_scc1 D_12
  s_sub_u32 s68, s68, 1
  s_cbranch_scc0 L_11
  s_mov_b32 s68, 0
D_12:
  s_cmp_ge_u32 s72, 32
  s_cselect_b32 s88, 1, 0
  s_mul_i32 s82, s3, 320
  v_bfe_u32 v42, v0, 4, 3
  v_mul_u32_u24 v42, 1280, v42
  v_lshrrev_b32 v33, 7, v0
  v_lshl_add_u32 v42, v33, 4, v42
  v_bfe_u32 v43, v0, 5, 3
  v_mul_u32_u24 v43, 1280, v43
  v_lshrrev_b32 v34, 8, v0
  v_lshl_add_u32 v43, v34, 4, v43
  v_bfe_u32 v34, v0, 4, 1
  v_lshl_add_u32 v43, v34, 3, v43
  buffer_load_dwordx4 v[32:35], v42, s[32:35], s82 offen offset:0
  buffer_load_dwordx4 v[36:39], v42, s[32:35], s82 offen offset:128
  buffer_load_dwordx2 v[40:41], v43, s[32:35], s82 offen offset:256
  buffer_load_dwordx4 v[48:51], v0, s[4:7], s87 offen offset:0 sc1
  buffer_load_dwordx4 v[52:55], v0, s[4:7], s87 offen offset:1024 sc1
  buffer_load_dwordx4 v[56:59], v0, s[4:7], s87 offen offset:2048 sc1
  buffer_load_dwordx4 v[60:63], v0, s[4:7], s87 offen offset:3072 sc1
  s_lshl_b32 s89, s69, 4
L_13:
  buffer_load_dwordx4 v[44:47], off, s[4:7], s89 sc1
  s_waitcnt vmcnt(40)
  s_barrier
  ds_read_b64_tr_b16 v[16:17], v8 offset:4096
  ds_read_b64_tr_b16 v[18:19], v8 offset:4224
  ds_read_b64_tr_b16 v[20:21], v14 offset:4096
  ds_read_b64_tr_b16 v[22:23], v14 offset:4224
  ds_read_b64_tr_b16 v[24:25], v8 offset:4128
  ds_read_b64_tr_b16 v[26:27], v8 offset:4256
  ds_read_b64_tr_b16 v[28:29], v14 offset:4128
  ds_read_b64_tr_b16 v[30:31], v14 offset:4256
  s_waitcnt lgkmcnt(0)
  s_barrier
  ds_write_b128 v1, v[16:19] offset:4096
  ds_write_b128 v1, v[20:23] offset:5120
  ds_write_b128 v1, v[24:27] offset:6144
  ds_write_b128 v1, v[28:31] offset:7168
  s_waitcnt vmcnt(36)
  s_barrier
  ds_read_b64_tr_b16 v[16:17], v8 offset:8192
  ds_read_b64_tr_b16 v[18:19], v8 offset:8320
  ds_read_b64_tr_b16 v[20:21], v14 offset:8192
  ds_read_b64_tr_b16 v[22:23], v14 offset:8320
  ds_read_b64_tr_b16 v[24:25], v8 offset:8224
  ds_read_b64_tr_b16 v[26:27], v8 offset:8352
  ds_read_b64_tr_b16 v[28:29], v14 offset:8224
  ds_read_b64_tr_b16 v[30:31], v14 offset:8352
  s_waitcnt lgkmcnt(0)
  s_barrier
  ds_write_b128 v1, v[16:19] offset:8192
  ds_write_b128 v1, v[20:23] offset:9216
  ds_write_b128 v1, v[24:27] offset:10240
  ds_write_b128 v1, v[28:31] offset:11264
  s_waitcnt vmcnt(32)
  s_barrier
  ds_read_b64_tr_b16 v[16:17], v8 offset:12288
  ds_read_b64_tr_b16 v[18:19], v8 offset:12416
  ds_read_b64_tr_b16 v[20:21], v14 offset:12288
  ds_read_b64_tr_b16 v[22:23], v14 offset:12416
  ds_read_b64_tr_b16 v[24:25], v8 offset:12320
  ds_read_b64_tr_b16 v[26:27], v8 offset:12448
  ds_read_b64_tr_b16 v[28:29], v14 offset:12320
  ds_read_b64_tr_b16 v[30:31], v14 offset:12448
  s_waitcnt lgkmcnt(0)
  s_barrier
  ds_write_b128 v1, v[16:19] offset:12288
  ds_write_b128 v1, v[20:23] offset:13312
  ds_write_b128 v1, v[24:27] offset:14336
  ds_write_b128 v1, v[28:31] offset:15360
  s_waitcnt vmcnt(28)
  s_barrier
  ds_read_b64_tr_b16 v[16:17], v8 offset:16384
  ds_read_b64_tr_b16 v[18:19], v8 offset:16512
  ds_read_b64_tr_b16 v[20:21], v14 offset:16384
  ds_read_b64_tr_b16 v[22:23], v14 offset:16512
  ds_read_b64_tr_b16 v[24:25], v8 offset:16416
  ds_read_b64_tr_b16 v[26:27], v8 offset:16544
  ds_read_b64_tr_b16 v[28:29], v14 offset:16416
  ds_read_b64_tr_b16 v[30:31], v14 offset:16544
  s_waitcnt lgkmcnt(0)
  s_barrier
  ds_write_b128 v1, v[16:19] offset:16384
  ds_write_b128 v1, v[20:23] offset:17408
  ds_write_b128 v1, v[24:27] offset:18432
  ds_write_b128 v1, v[28:31] offset:19456
  s_waitcnt vmcnt(24)
  s_barrier
  ds_read_b64_tr_b16 v[16:17], v10 offset:20480
  ds_read_b64_tr_b16 v[18:19], v10 offset:20736
  ds_read_b64_tr_b16 v[20:21], v10 offset:21504
  ds_read_b64_tr_b16 v[22:23], v10 offset:21760
  ds_read_b64_tr_b16 v[24:25], v15 offset:20480
  ds_read_b64_tr_b16 v[26:27], v15 offset:20736
  ds_read_b64_tr_b16 v[28:29], v15 offset:21504
  ds_read_b64_tr_b16 v[30:31], v15 offset:21760
  s_waitcnt lgkmcnt(0)
  s_barrier
  ds_write_b128 v1, v[16:19] offset:20480
  ds_write_b128 v1, v[20:23] offset:21504
  ds_write_b128 v1, v[24:27] offset:22528
  ds_write_b128 v1, v[28:31] offset:23552
  s_waitcnt vmcnt(20)
  s_barrier
  ds_read_b64_tr_b16 v[16:17], v10 offset:24576
  ds_read_b64_tr_b16 v[18:19], v10 offset:24832
  ds_read_b64_tr_b16 v[20:21], v10 offset:25600
  ds_read_b64_tr_b16 v[22:23], v10 offset:25856
  ds_read_b64_tr_b16 v[24:25], v15 offset:24576
  ds_read_b64_tr_b16 v[26:27], v15 offset:24832
  ds_read_b64_tr_b16 v[28:29], v15 offset:25600
  ds_read_b64_tr_b16 v[30:31], v15 offset:25856
  s_waitcnt lgkmcnt(0)
  s_barrier
  ds_write_b128 v1, v[16:19] offset:24576
  ds_write_b128 v1, v[20:23] offset:25600
  ds_write_b128 v1, v[24:27] offset:26624
  ds_write_b128 v1, v[28:31] offset:27648
  s_waitcnt vmcnt(16)
  s_barrier
  ds_read_b64_tr_b16 v[16:17], v10 offset:28672
  ds_read_b64_tr_b16 v[18:19], v10 offset:28928
  ds_read_b64_tr_b16 v[20:21], v10 offset:29696
  ds_read_b64_tr_b16 v[22:23], v10 offset:29952
  ds_read_b64_tr_b16 v[24:25], v15 offset:28672
  ds_read_b64_tr_b16 v[26:27], v15 offset:28928
  ds_read_b64_tr_b16 v[28:29], v15 offset:29696
  ds_read_b64_tr_b16 v[30:31], v15 offset:29952
  s_waitcnt lgkmcnt(0)
  s_barrier
  ds_write_b128 v1, v[16:19] offset:28672
  ds_write_b128 v1, v[20:23] offset:29696
  ds_write_b128 v1, v[24:27] offset:30720
  ds_write_b128 v1, v[28:31] offset:31744
  s_waitcnt vmcnt(12)
  s_barrier
  ds_read_b64_tr_b16 v[16:17], v10 offset:32768
  ds_read_b64_tr_b16 v[18:19], v10 offset:33024
  ds_read_b64_tr_b16 v[20:21], v10 offset:33792
  ds_read_b64_tr_b16 v[22:23], v10 offset:34048
  ds_read_b64_tr_b16 v[24:25], v15 offset:32768
  ds_read_b64_tr_b16 v[26:27], v15 offset:33024
  ds_read_b64_tr_b16 v[28:29], v15 offset:33792
  ds_read_b64_tr_b16 v[30:31], v15 offset:34048
  s_waitcnt lgkmcnt(0)
  s_barrier
  ds_write_b128 v1, v[16:19] offset:32768
  ds_write_b128 v1, v[20:23] offset:33792
  ds_write_b128 v1, v[24:27] offset:34816
  ds_write_b128 v1, v[28:31] offset:35840
  s_waitcnt vmcnt(8)
  s_barrier
  ds_read_b64_tr_b16 v[224:225], v9 offset:0
  ds_read_b64_tr_b16 v[226:227], v9 offset:128
  ds_read_b64_tr_b16 v[228:229], v9 offset:4096
  ds_read_b64_tr_b16 v[230:231], v9 offset:4224
  ds_read_b64_tr_b16 v[232:233], v9 offset:32
  ds_read_b64_tr_b16 v[234:235], v9 offset:160
  ds_read_b64_tr_b16 v[236:237], v9 offset:4128
  ds_read_b64_tr_b16 v[238:239], v9 offset:4256
  s_waitcnt lgkmcnt(0)
  s_barrier
  s_lshr_b32 s76, s69, 4
  s_lshl_b32 s77, s76, 3
  s_and_b32 s82, s69, 7
  s_add_u32 s77, s77, s82
  s_add_u32 s77, s77, 32
  s_cmp_eq_u32 s3, 1
  s_cselect_b32 s77, s69, s77
  s_cmp_ge_u32 s77, 24
  s_cselect_b32 s82, 16, 0
  s_add_u32 s77, s77, s82
  s_mul_i32 s76, s76, 24
  s_add_u32 s76, s76, s69
  s_add_u32 s76, s76, 24
  s_cmp_eq_u32 s3, 0
  s_cselect_b32 s76, s76, s77
  s_bfe_u32 s81, s69, 0x10003
  s_add_u32 s81, s81, s3
  s_cmp_lt_u32 s81, 3
  s_cselect_b32 s81, 1, 0
  s_lshl_b32 s77, s76, 7
  s_add_u32 s77, s77, 327680
  s_lshl_b32 s76, s76, 12
  s_add_u32 s76, s76, 1048576
  s_mov_b32 s72, 0
  s_mov_b32 s80, 0
  s_lshl_b32 s73, s85, 6
  s_add_u32 s73, s73, 16777216
  s_lshl_b32 s74, s85, 5
  s_add_u32 s74, s74, 83886080
  s_lshr_b32 s75, s3, 1
  s_lshl_b32 s75, s75, 3
  s_add_u32 s75, s75, s3
  s_lshl_b32 s75, s75, 14
  s_lshl_b32 s82, s69, 7
  s_add_u32 s75, s75, s82
  s_add_u32 s75, s75, 1048576
  s_mul_i32 s84, s3, 2560
  s_add_u32 s66, s69, s3
  s_cmp_eq_u32 s66, 0
  s_cselect_b32 s66, 2, 99
  s_cmp_eq_u32 s3, 3
  s_cselect_b32 s64, 0xff, 0
  s_mov_b32 s65, 0
  s_mov_b32 s52, 0xaaaaaaaa
  s_mov_b32 s53, s52
  s_mov_b32 s54, 0x03030303
  s_mov_b32 s55, s54
  s_lshl_b64 s[56:57], s[54:55], 2
  s_lshl_b64 s[58:59], s[54:55], 4
  s_lshl_b64 s[60:61], s[54:55], 6
  s_lshl_b32 s85, s69, 7
  s_add_u32 s85, s85, 4096
  s_lshl_b32 s86, s3, 10
  s_lshl_b32 s83, s3, 8
  s_add_u32 s70, s87, 4096
  s_add_u32 s71, s87, 8192
  s_mov_b32 s12, 0x3f803f80
  s_mov_b32 s13, s12
  s_mov_b32 s14, 0x3f003f00
  s_mov_b32 s15, s14
  s_add_u32 s16, s75, 32768
  s_add_u32 s17, s75, 65536
  s_add_u32 s18, s75, 98304
  s_add_u32 s19, s75, 131072
  s_add_u32 s20, s84, 327680
  s_mov_b32 s78, s20
  ds_write_b128 v0, v[4:7] offset:15360
  s_lshl_b32 s89, s69, 4
  s_branch L_14x
L_14:
  buffer_load_dwordx4 v[44:47], off, s[4:7], s89 sc1
L_14x:
  s_waitcnt vmcnt(0)
  v_min_u32 v44, v44, v45
  v_min3_u32 v44, v44, v46, v47
  s_nop 0
  v_readfirstlane_b32 s80, v44
  s_lshl_b32 s80, s80, 2
  s_cmp_gt_u32 s80, s72
  s_cbranch_scc1 D_15
  s_sub_u32 s68, s68, 1
  s_cbranch_scc0 L_14
  s_mov_b32 s68, 0
D_15:
  s_waitcnt vmcnt(0) lgkmcnt(0)
  s_mov_b32 s82, 0x05040100
  s_mov_b32 s89, 0x07060302
  v_perm_b32 v8, v33, v32, s82
  v_perm_b32 v33, v33, v32, s89
  v_mov_b32 v32, v8
  v_perm_b32 v8, v35, v34, s82
  v_perm_b32 v35, v35, v34, s89
  v_mov_b32 v34, v8
  v_perm_b32 v8, v37, v36, s82
  v_perm_b32 v37, v37, v36, s89
  v_mov_b32 v36, v8
  v_perm_b32 v8, v39, v38, s82
  v_perm_b32 v39, v39, v38, s89
  v_mov_b32 v38, v8
  v_perm_b32 v8, v41, v40, s82
  v_perm_b32 v41, v41, v40, s89
  v_mov_b32 v40, v8
  v_lshrrev_b32 v25, 1, v0
  s_cmp_eq_u32 s88, 0
  s_cbranch_scc1 CH_W1
CH_W0:
  v_mov_b64 v[8:9], 0
  v_mov_b64 v[10:11], 0
  v_mov_b64 v[12:13], 0
  v_mov_b64 v[14:15], 0
  v_mov_b64 v[16:17], 0
  v_mov_b64 v[18:19], 0
  v_mov_b64 v[20:21], 0
  v_mov_b64 v[22:23], 0
  v_add_u32 v26, s84, v0
  v_add_u32 v27, s84, v25
  s_waitcnt vmcnt(2)
  ds_write_b128 v26, v[32:35]
  v_max3_u32 v24, v32, v33, v34
  s_waitcnt vmcnt(1)
  ds_write_b128 v26, v[36:39] offset:1024
  v_max3_u32 v24, v24, v35, v36
  v_max3_u32 v24, v24, v37, v38
  v_max_u32 v24, v24, v39
  s_waitcnt vmcnt(0)
  ds_write_b64 v27, v[40:41] offset:2048
  v_max3_u32 v24, v24, v40, v41
  v_cmp_eq_u32 vcc, -1, v24
  s_cbranch_vccnz CH_F0
CH_G0:
  buffer_load_dwordx4 v[40:43], v0, s[4:7], s70 offen offset:0 sc1
  buffer_load_dwordx4 v[44:47], v0, s[4:7], s70 offen offset:1024 sc1
  s_waitcnt lgkmcnt(0)
  s_barrier
  ds_read_b128 v[24:27], v0 offset:0
  ds_read_b128 v[4:7], v0 offset:1024
  ds_read_b128 v[28:31], v0 offset:2048
  buffer_load_dwordx4 v[32:35], v0, s[4:7], s73 offen offset:0 sc1 nt
  buffer_load_dwordx4 v[36:39], v0, s[4:7], s73 offen offset:1024 sc1 nt
  s_waitcnt lgkmcnt(2)
  v_smfmac_f32_16x16x64_bf16 v[8:11], v[24:27], v[48:55], v2
  ds_read_b128 v[48:51], v1 offset:0
  ds_read_b128 v[52:55], v1 offset:1024
  v_smfmac_f32_16x16x64_bf16 v[12:15], v[24:27], v[56:63], v2
  ds_read_b128 v[56:59], v1 offset:2048
  ds_read_b128 v[60:63], v1 offset:3072
  v_smfmac_f32_16x16x64_bf16 v[16:19], v[24:27], a[0:7], v2
  v_smfmac_f32_16x16x64_bf16 v[20:23], v[24:27], a[8:15], v2
  ds_read_b128 v[24:27], v0 offset:3072
  s_waitcnt lgkmcnt(6)
  v_smfmac_f32_16x16x64_bf16 v[8:11], v[4:7], a[32:39], v2
  v_smfmac_f32_16x16x64_bf16 v[12:15], v[4:7], a[40:47], v2
  s_waitcnt lgkmcnt(3)
  v_smfmac_f32_16x16x64_bf16 v[16:19], v[4:7], v[48:55], v2
  ds_read_b128 v[48:51], v1 offset:4096
  ds_read_b128 v[52:55], v1 offset:5120
  s_waitcnt lgkmcnt(3)
  v_smfmac_f32_16x16x64_bf16 v[20:23], v[4:7], v[56:63], v2
  ds_read_b128 v[4:7], v0 offset:4096
  ds_read_b128 v[56:59], v1 offset:6144
  ds_read_b128 v[60:63], v1 offset:7168
  v_smfmac_f32_16x16x64_bf16 v[8:11], v[28:31], a[64:71], v2
  v_smfmac_f32_16x16x64_bf16 v[12:15], v[28:31], a[72:79], v2
  v_smfmac_f32_16x16x64_bf16 v[16:19], v[28:31], a[80:87], v2
  v_smfmac_f32_16x16x64_bf16 v[20:23], v[28:31], a[88:95], v2
  ds_read_b128 v[28:31], v0 offset:5120
  s_waitcnt lgkmcnt(6)
  s_waitcnt lgkmcnt(4)
  v_smfmac_f32_16x16x64_bf16 v[8:11], v[24:27], v[48:55], v2
  ds_read_b128 v[48:51], v1 offset:8192
  ds_read_b128 v[52:55], v1 offset:9216
  s_waitcnt lgkmcnt(3)
  v_smfmac_f32_16x16x64_bf16 v[12:15], v[24:27], v[56:63], v2
  ds_read_b128 v[56:59], v1 offset:10240
  ds_read_b128 v[60:63], v1 offset:11264
  s_waitcnt vmcnt(2)
  v_smfmac_f32_16x16x64_bf16 v[16:19], v[24:27], v[40:47], v2
  buffer_load_dwordx4 v[40:43], v0, s[4:7], s70 offen offset:2048 sc1
  v_smfmac_f32_16x16x64_bf16 v[20:23], v[24:27], v[248:255], v2
  ds_read_b128 v[24:27], v0 offset:6144
  v_smfmac_f32_16x16x64_bf16 v[8:11], v[4:7], a[144:151], v2
  v_mov_b32 v3, s72
  v_smfmac_f32_16x16x64_bf16 v[12:15], v[4:7], a[152:159], v2
  s_waitcnt lgkmcnt(3)
  v_smfmac_f32_16x16x64_bf16 v[16:19], v[4:7], v[48:55], v2
  ds_read_b128 v[48:51], v1 offset:12288
  ds_read_b128 v[52:55], v1 offset:13312
  buffer_load_dwordx4 v[44:47], v0, s[4:7], s70 offen offset:3072 sc1
  s_waitcnt lgkmcnt(3)
  v_smfmac_f32_16x16x64_bf16 v[20:23], v[4:7], v[56:63], v2
  ds_read_b128 v[4:7], v0 offset:7168
  ds_read_b128 v[56:59], v1 offset:14336
  ds_read_b128 v[60:63], v1 offset:15360
  v_smfmac_f32_16x16x64_bf16 v[8:11], v[28:31], a[192:199], v2
  v_smfmac_f32_16x16x64_bf16 v[12:15], v[28:31], a[200:207], v2
  v_smfmac_f32_16x16x64_bf16 v[16:19], v[28:31], a[208:215], v2
  v_smfmac_f32_16x16x64_bf16 v[20:23], v[28:31], a[216:223], v2
  ds_read_b128 v[28:31], v0 offset:8192
  s_waitcnt lgkmcnt(6)
  s_waitcnt lgkmcnt(4)
  v_smfmac_f32_16x16x64_bf16 v[8:11], v[24:27], v[48:55], v2
  ds_read_b128 v[48:51], v1 offset:16384
  ds_read_b128 v[52:55], v1 offset:17408
  s_waitcnt lgkmcnt(3)
  v_smfmac_f32_16x16x64_bf16 v[12:15], v[24:27], v[56:63], v2
  ds_read_b128 v[56:59], v1 offset:18432
  ds_read_b128 v[60:63], v1 offset:19456
  v_smfmac_f32_16x16x64_bf16 v[16:19], v[24:27], v[64:71], v2
  s_mov_b64 exec, s[64:65]
  buffer_store_dwordx4 v[0:3], v0, s[4:7], s85 offen sc1
  s_mov_b64 exec, -1
  v_smfmac_f32_16x16x64_bf16 v[20:23], v[24:27], v[72:79], v2
  ds_read_b128 v[24:27], v0 offset:9216
  v_smfmac_f32_16x16x64_bf16 v[8:11], v[4:7], v[96:103], v2
  v_smfmac_f32_16x16x64_bf16 v[12:15], v[4:7], v[104:111], v2
  s_waitcnt lgkmcnt(3)
  v_smfmac_f32_16x16x64_bf16 v[16:19], v[4:7], v[48:55], v2
  s_waitcnt lgkmcnt(1)
  v_smfmac_f32_16x16x64_bf16 v[20:23], v[4:7], v[56:63], v2
  ds_read_b128 v[4:7], v0 offset:15360
  ds_read_b128 v[48:51], v0 offset:0
  ds_read_b128 v[52:55], v0 offset:1024
  v_smfmac_f32_16x16x64_bf16 v[8:11], v[28:31], v[144:151], v2
  v_smfmac_f32_16x16x64_bf16 v[12:15], v[28:31], v[152:159], v2
  s_waitcnt lgkmcnt(3)
  v_smfmac_f32_16x16x64_bf16 v[8:11], v[24:27], v[208:215], v2
  v_smfmac_f32_16x16x64_bf16 v[12:15], v[24:27], v[216:223], v2
  v_smfmac_f32_16x16x64_bf16 v[16:19], v[28:31], v[160:167], v2
  v_cvt_pk_bf16_f32 v56, v8, v9
  v_smfmac_f32_16x16x64_bf16 v[20:23], v[28:31], v[168:175], v2
  v_cvt_pk_bf16_f32 v57, v10, v11
  v_cvt_pk_bf16_f32 v58, v12, v13
  buffer_load_dwordx4 v[28:31], v0, s[4:7], s73 offen offset:3072 sc1 nt
  v_smfmac_f32_16x16x64_bf16 v[16:19], v[24:27], v[240:247], v2
  v_cvt_pk_bf16_f32 v59, v14, v15
  s_waitcnt lgkmcnt(2)
  v_mfma_f32_16x16x16_bf16 v[8:11], v[56:57], v[4:5], 0
  v_mfma_f32_16x16x16_bf16 v[12:15], v[58:59], v[4:5], 0
  v_cvt_pk_bf16_f32 v60, v16, v17
  v_cvt_pk_bf16_f32 v61, v18, v19
  s_nop 1
  v_cvt_pk_bf16_f32 v56, v8, v9
  v_mfma_f32_16x16x16_bf16 v[16:19], v[60:61], v[4:5], 0
  v_cvt_pk_bf16_f32 v57, v10, v11
  v_mov_b64 v[8:9], 0
  v_mov_b64 v[10:11], 0
  v_cvt_pk_bf16_f32 v58, v12, v13
  v_cvt_pk_bf16_f32 v59, v14, v15
  v_mov_b64 v[12:13], 0
  v_mov_b64 v[14:15], 0
  s_waitcnt lgkmcnt(1)
  v_smfmac_f32_16x16x64_bf16 v[8:11], v[48:51], a[16:23], v2
  v_cvt_pk_bf16_f32 v60, v16, v17
  v_smfmac_f32_16x16x64_bf16 v[12:15], v[48:51], a[24:31], v2
  v_cvt_pk_bf16_f32 v61, v18, v19
  ds_read_b128 v[48:51], v0 offset:2048
  s_waitcnt lgkmcnt(1)
  v_smfmac_f32_16x16x64_bf16 v[8:11], v[52:55], a[48:55], v2
  v_smfmac_f32_16x16x64_bf16 v[12:15], v[52:55], a[56:63], v2
  ds_read_b128 v[52:55], v0 offset:3072
  s_waitcnt lgkmcnt(1)
  v_smfmac_f32_16x16x64_bf16 v[8:11], v[48:51], a[96:103], v2
  v_smfmac_f32_16x16x64_bf16 v[12:15], v[48:51], a[104:111], v2
  ds_read_b128 v[48:51], v0 offset:4096
  s_waitcnt vmcnt(2)
  v_smfmac_f32_16x16x64_bf16 v[20:23], v[24:27], v[40:47], v2
  buffer_load_dwordx4 v[24:27], v0, s[4:7], s73 offen offset:2048 sc1 nt
  v_mfma_f32_16x16x32_bf16 v[40:43], v[32:35], v[56:59], 0
  ds_read_b128 v[32:35], v0 offset:5120
  v_add_u32 v16, s86, v0
  v_bfe_u32 v17, v0, 1, 8
  v_mfma_f32_16x16x32_bf16 v[44:47], v[36:39], v[56:59], 0
  ds_read_b128 v[36:39], v0 offset:6144
  v_cvt_pk_bf16_f32 v62, v20, v21
  v_cvt_pk_bf16_f32 v63, v22, v23
  v_add_u32 v17, s83, v17
  s_nop 0
  v_mfma_f32_16x16x16_bf16 v[20:23], v[62:63], v[4:5], 0
  s_mov_b64 exec, s[92:93]
  s_nop 0
  v_mov_b64 v[40:41], v[44:45]
  v_mov_b64 v[42:43], v[46:47]
  s_mov_b64 exec, -1
  ds_write_b128 v16, v[40:43] offset:10240
  s_nop 1
  v_cvt_pk_bf16_f32 v62, v20, v21
  v_cvt_pk_bf16_f32 v63, v22, v23
  s_nop 1
  v_mfma_f32_16x16x32_bf16 v[20:23], v[60:63], v[56:59], 0
  s_mov_b64 exec, s[92:93]
  buffer_store_dwordx4 v[60:63], v0, s[4:7], s74 offen sc1
  s_waitcnt lgkmcnt(4)
  v_smfmac_f32_16x16x64_bf16 v[8:11], v[52:55], a[128:135], v2
  s_nop 3
  v_mov_b64 v[20:21], v[22:23]
  s_mov_b64 exec, -1
  ds_write_b64 v17, v[20:21] offset:14336
  v_smfmac_f32_16x16x64_bf16 v[12:15], v[52:55], a[136:143], v2
  ds_read_b128 v[52:55], v0 offset:7168
  v_bfe_u32 v62, v0, 1, 8
  s_waitcnt lgkmcnt(5)
  v_smfmac_f32_16x16x64_bf16 v[8:11], v[48:51], a[160:167], v2
  v_smfmac_f32_16x16x64_bf16 v[12:15], v[48:51], a[168:175], v2
  ds_read_b128 v[48:51], v0 offset:8192
  s_waitcnt lgkmcnt(2)
  s_barrier
  ds_read_b128 v[40:43], v0 offset:10240
  ds_read_b64 v[56:57], v62 offset:14336
  ds_read_b128 v[44:47], v0 offset:11264
  ds_read_b64 v[58:59], v62 offset:14592
  ds_read_b128 v[16:19], v0 offset:12288
  ds_read_b64 v[60:61], v62 offset:14848
  ds_read_b128 v[20:23], v0 offset:13312
  ds_read_b64 v[62:63], v62 offset:15104
  v_smfmac_f32_16x16x64_bf16 v[8:11], v[32:35], a[224:231], v2
  v_smfmac_f32_16x16x64_bf16 v[12:15], v[32:35], a[232:239], v2
  ds_read_b128 v[32:35], v0 offset:9216
  v_smfmac_f32_16x16x64_bf16 v[8:11], v[36:39], v[80:87], v2
  v_smfmac_f32_16x16x64_bf16 v[12:15], v[36:39], v[88:95], v2
  s_waitcnt lgkmcnt(10)
  v_smfmac_f32_16x16x64_bf16 v[8:11], v[52:55], v[112:119], v2
  v_smfmac_f32_16x16x64_bf16 v[12:15], v[52:55], v[120:127], v2
  s_waitcnt lgkmcnt(9)
  v_smfmac_f32_16x16x64_bf16 v[8:11], v[48:51], v[176:183], v2
  v_smfmac_f32_16x16x64_bf16 v[12:15], v[48:51], v[184:191], v2
  s_waitcnt lgkmcnt(5)
  v_pk_add_f32 v[40:41], v[40:41], v[44:45]
  v_pk_add_f32 v[42:43], v[42:43], v[46:47]
  v_pk_add_f32 v[56:57], v[56:57], v[58:59]
  s_waitcnt lgkmcnt(1)
  v_pk_add_f32 v[16:17], v[16:17], v[20:21]
  v_pk_add_f32 v[18:19], v[18:19], v[22:23]
  v_pk_add_f32 v[60:61], v[60:61], v[62:63]
  v_pk_add_f32 v[40:41], v[40:41], v[16:17]
  v_pk_add_f32 v[42:43], v[42:43], v[18:19]
  v_pk_add_f32 v[44:45], v[56:57], v[60:61]
  buffer_load_dwordx4 v[56:59], v0, s[4:7], s71 offen offset:2048 sc1
  v_max3_f32 v22, v40, v41, v42
  v_max3_f32 v22, v22, v43, v44
  v_max_f32 v22, v22, v45
  s_waitcnt lgkmcnt(0)
  v_smfmac_f32_16x16x64_bf16 v[8:11], v[32:35], v[224:231], v2
  v_max_f32_dpp v22, v22, v22 row_ror:8 row_mask:0xf bank_mask:0xf
  v_mov_b32 v23, v22
  v_smfmac_f32_16x16x64_bf16 v[12:15], v[32:35], v[232:239], v2
  s_nop 0
  v_permlane16_swap_b32 v22, v23
  v_max_f32 v22, v22, v23
  v_mov_b32 v23, v22
  buffer_load_dwordx4 v[60:63], v0, s[4:7], s71 offen offset:3072 sc1
  s_nop 0
  v_permlane32_swap_b32 v22, v23
  v_max_f32 v22, v22, v23
  v_mul_f32 v22, s94, v22
  v_fma_f32 v40, v40, s94, -v22
  v_fma_f32 v41, v41, s94, -v22
  v_fma_f32 v42, v42, s94, -v22
  v_fma_f32 v43, v43, s94, -v22
  v_fma_f32 v44, v44, s94, -v22
  v_fma_f32 v45, v45, s94, -v22
  v_exp_f32 v40, v40
  v_exp_f32 v41, v41
  v_exp_f32 v42, v42
  v_exp_f32 v43, v43
  buffer_load_dwordx4 v[48:51], v0, s[4:7], s71 offen offset:0 sc1
  v_exp_f32 v44, v44
  v_exp_f32 v45, v45
  v_cvt_pk_bf16_f32 v16, v40, v41
  v_cvt_pk_bf16_f32 v17, v42, v43
  v_cvt_pk_bf16_f32 v20, v44, v45
  v_mov_b64 v[36:37], s[12:13]
  v_mov_b64 v[38:39], s[12:13]
  v_mov_b32_dpp v18, v16 row_ror:8 row_mask:0xf bank_mask:0xf
  v_mov_b32_dpp v19, v17 row_ror:8 row_mask:0xf bank_mask:0xf
  v_mov_b32_dpp v21, v20 row_ror:8 row_mask:0xf bank_mask:0xf
  buffer_load_dwordx4 v[52:55], v0, s[4:7], s71 offen offset:1024 sc1
  v_mfma_f32_16x16x32_bf16 v[40:43], v[36:39], v[16:19], 0
  v_cvt_pk_bf16_f32 v44, v8, v9
  v_cvt_pk_bf16_f32 v45, v10, v11
  s_waitcnt vmcnt(5)
  v_mfma_f32_16x16x32_bf16 v[8:11], v[24:27], v[16:19], 0
  v_mov_b64 v[34:35], s[14:15]
  v_cvt_pk_bf16_f32 v46, v12, v13
  v_cvt_pk_bf16_f32 v47, v14, v15
  v_mfma_f32_16x16x16_bf16 v[40:43], v[34:35], v[20:21], v[40:43]
  v_lshl_add_u32 v32, s3, 9, v6
  v_mfma_f32_16x16x32_bf16 v[12:15], v[28:31], v[16:19], 0
  buffer_store_dwordx4 v[44:47], v0, s[4:7], s74 offen offset:1024 sc1
  v_mfma_f32_16x16x16_bf16 v[8:11], v[44:45], v[20:21], v[8:11]
  v_rcp_f32 v22, v40
  v_mfma_f32_16x16x16_bf16 v[12:15], v[46:47], v[20:21], v[12:15]
  s_cmp_eq_u32 s72, 63
  s_cbranch_scc1 CH_END
  s_add_u32 s73, s73, 524288
  s_add_u32 s74, s74, 262144
  v_mul_f32 v8, v8, v22
  v_mul_f32 v9, v9, v22
  v_mul_f32 v10, v10, v22
  v_mul_f32 v11, v11, v22
  v_pk_mul_f32 v[12:13], v[12:13], v[22:23] op_sel_hi:[1,0]
  v_pk_mul_f32 v[14:15], v[14:15], v[22:23] op_sel_hi:[1,0]
  v_cvt_pk_bf16_f32 v16, v8, v9
  v_cvt_pk_bf16_f32 v17, v10, v11
  v_cvt_pk_bf16_f32 v18, v12, v13
  v_cvt_pk_bf16_f32 v19, v14, v15
  s_mov_b64 exec, s[90:91]
  ds_write_b128 v32, v[16:19]
  s_mov_b64 exec, -1
  ds_read_b128 v[32:35], v1 offset:20480
  ds_read_b128 v[36:39], v1 offset:21504
  ds_read_b128 v[40:43], v1 offset:22528
  ds_read_b128 v[44:47], v1 offset:23552
  v_mov_b64 v[24:25], 0
  v_mov_b64 v[26:27], 0
  v_mov_b64 v[28:29], 0
  v_mov_b64 v[30:31], 0
  s_waitcnt lgkmcnt(4)
  s_barrier
  ds_read_b128 v[8:11], v6 offset:0
  ds_read_b128 v[12:15], v6 offset:512
  ds_read_b128 v[16:19], v6 offset:1024
  ds_read_b128 v[20:23], v6 offset:1536
  s_waitcnt lgkmcnt(3)
  v_smfmac_f32_16x16x64_bf16 v[24:27], v[8:11], v[32:39], v2
  ds_read_b128 v[32:35], v1 offset:24576
  ds_read_b128 v[36:39], v1 offset:25600
  s_waitcnt lgkmcnt(4)
  v_smfmac_f32_16x16x64_bf16 v[24:27], v[12:15], v[40:47], v2
  ds_read_b128 v[40:43], v1 offset:26624
  ds_read_b128 v[44:47], v1 offset:27648
  s_waitcnt lgkmcnt(5)
  s_waitcnt vmcnt(1)
  v_smfmac_f32_16x16x64_bf16 v[24:27], v[16:19], v[48:55], v2
  buffer_load_dwordx4 v[48:51], v0, s[4:7], s87 offen offset:0 sc1
  s_waitcnt lgkmcnt(4)
  v_smfmac_f32_16x16x64_bf16 v[24:27], v[20:23], v[56:63], v2
  v_smfmac_f32_16x16x64_bf16 v[28:31], v[8:11], a[112:119], v2
  buffer_load_dwordx4 v[52:55], v0, s[4:7], s87 offen offset:1024 sc1
  v_smfmac_f32_16x16x64_bf16 v[28:31], v[12:15], a[120:127], v2
  v_cvt_pk_bf16_f32 v4, v24, v25
  v_mov_b64 v[24:25], 0
  s_waitcnt lgkmcnt(2)
  v_smfmac_f32_16x16x64_bf16 v[28:31], v[16:19], v[32:39], v2
  v_cvt_pk_bf16_f32 v5, v26, v27
  v_mov_b64 v[26:27], 0
  ds_read_b128 v[32:35], v1 offset:28672
  ds_read_b128 v[36:39], v1 offset:29696
  s_waitcnt lgkmcnt(2)
  v_smfmac_f32_16x16x64_bf16 v[28:31], v[20:23], v[40:47], v2
  v_bfi_b32 v4, 1, s72, v4
  ds_read_b128 v[40:43], v1 offset:30720
  ds_read_b128 v[44:47], v1 offset:31744
  buffer_load_dwordx4 v[56:59], v0, s[4:7], s87 offen offset:2048 sc1
  v_smfmac_f32_16x16x64_bf16 v[24:27], v[8:11], a[176:183], v2
  buffer_store_dwordx2 v[4:5], v7, s[4:7], s75 offen
  v_smfmac_f32_16x16x64_bf16 v[24:27], v[12:15], a[184:191], v2
  v_cvt_pk_bf16_f32 v4, v28, v29
  v_mov_b64 v[28:29], 0
  v_smfmac_f32_16x16x64_bf16 v[24:27], v[16:19], a[240:247], v2
  v_cvt_pk_bf16_f32 v5, v30, v31
  v_mov_b64 v[30:31], 0
  v_smfmac_f32_16x16x64_bf16 v[24:27], v[20:23], a[248:255], v2
  v_bfi_b32 v4, 1, s72, v4
  buffer_load_dwordx4 v[60:63], v0, s[4:7], s87 offen offset:3072 sc1
  s_waitcnt lgkmcnt(2)
  v_smfmac_f32_16x16x64_bf16 v[28:31], v[8:11], v[32:39], v2
  buffer_store_dwordx2 v[4:5], v7, s[4:7], s16 offen
  ds_read_b128 v[32:35], v1 offset:32768
  ds_read_b128 v[36:39], v1 offset:33792
  s_waitcnt lgkmcnt(2)
  v_smfmac_f32_16x16x64_bf16 v[28:31], v[12:15], v[40:47], v2
  v_cvt_pk_bf16_f32 v4, v24, v25
  v_mov_b64 v[24:25], 0
  ds_read_b128 v[40:43], v1 offset:34816
  ds_read_b128 v[44:47], v1 offset:35840
  v_smfmac_f32_16x16x64_bf16 v[28:31], v[16:19], v[128:135], v2
  v_cvt_pk_bf16_f32 v5, v26, v27
  v_mov_b64 v[26:27], 0
  v_smfmac_f32_16x16x64_bf16 v[28:31], v[20:23], v[136:143], v2
  v_bfi_b32 v4, 1, s72, v4
  v_smfmac_f32_16x16x64_bf16 v[24:27], v[8:11], v[192:199], v2
  buffer_store_dwordx2 v[4:5], v7, s[4:7], s17 offen
  v_smfmac_f32_16x16x64_bf16 v[24:27], v[12:15], v[200:207], v2
  v_cvt_pk_bf16_f32 v4, v28, v29
  s_waitcnt lgkmcnt(2)
  v_smfmac_f32_16x16x64_bf16 v[24:27], v[16:19], v[32:39], v2
  v_cvt_pk_bf16_f32 v5, v30, v31
  v_bfi_b32 v4, 1, s72, v4
  s_waitcnt lgkmcnt(0)
  v_smfmac_f32_16x16x64_bf16 v[24:27], v[20:23], v[40:47], v2
  buffer_store_dwordx2 v[4:5], v7, s[4:7], s18 offen
  s_add_u32 s89, s72, 1
  s_and_b32 s78, s89, 3
  s_mul_i32 s78, s78, 10240
  s_add_u32 s79, s77, s78
  s_add_u32 s78, s78, s20
  s_cmp_eq_u32 s81, 0
  s_nop 0
  v_cvt_pk_bf16_f32 v24, v24, v25
  v_cvt_pk_bf16_f32 v25, v26, v27
  v_bfi_b32 v24, 1, s72, v24
  buffer_store_dwordx2 v[24:25], v7, s[4:7], s19 offen
  s_mov_b32 s72, s89
  s_cbranch_scc1 CH_N0
  s_cmp_eq_u32 s3, 0
  s_cbranch_scc0 CH_E0
  v_mov_b32 v29, 0x3f80
  v_mov_b32 v30, 1.0
  v_cndmask_b32 v29, v29, v30, s[52:53]
  v_and_b32 v3, 0x30, v0
  v_and_or_b32 v3, v7, 64, v3
  v_lshrrev_b32 v4, 13, v7
  v_lshl_or_b32 v3, v4, 3, v3
  v_bfe_u32 v4, v7, 5, 1
  v_lshl_or_b32 v3, v4, 2, v3
  v_cndmask_b32 v24, 0, v29, s[54:55]
  v_cndmask_b32 v25, 0, v29, s[56:57]
  v_cndmask_b32 v26, 0, v29, s[58:59]
  v_cndmask_b32 v27, 0, v29, s[60:61]
  s_add_u32 s89, s72, 2
  s_and_b32 s89, s89, 3
  s_mul_i32 s89, s89, 10240
  s_add_u32 s89, s89, s77
  s_waitcnt vmcnt(0)
CH_P0:
  buffer_load_dwordx4 v[8:11], v0, s[4:7], s76 offen offset:0 sc1
  buffer_load_dwordx4 v[12:15], v0, s[4:7], s76 offen offset:1024 sc1
  buffer_load_dwordx4 v[16:19], v0, s[4:7], s76 offen offset:2048 sc1
  buffer_load_dwordx4 v[20:23], v0, s[4:7], s76 offen offset:3072 sc1
  s_sub_u32 s68, s68, 1
  s_cselect_b32 s68, 0, s68
  s_cselect_b32 s82, 1, 0
  s_waitcnt vmcnt(3)
  v_mfma_f32_16x16x32_bf16 v[28:31], v[8:11], v[24:27], 0
  v_bitop3_b32 v4, v8, v10, s72 bitop3:0xbd
  s_waitcnt vmcnt(2)
  v_mfma_f32_16x16x32_bf16 v[28:31], v[12:15], v[24:27], v[28:31]
  v_bitop3_b32 v5, v12, v14, s72 bitop3:0xbd
  v_or_b32 v4, v4, v5
  s_waitcnt vmcnt(1)
  v_mfma_f32_16x16x32_bf16 v[28:31], v[16:19], v[24:27], v[28:31]
  v_bitop3_b32 v5, v16, v18, s72 bitop3:0xbd
  v_or_b32 v4, v4, v5
  s_waitcnt vmcnt(0)
  v_mfma_f32_16x16x32_bf16 v[28:31], v[20:23], v[24:27], v[28:31]
  v_bitop3_b32 v5, v20, v22, s72 bitop3:0xbd
  v_bitop3_b32 v4, v4, v5, 1 bitop3:0xa8
  v_cmp_lt_u32 vcc, s82, v4
  s_cbranch_vccnz CH_P0
CH_PD0:
  v_mov_b32 v5, -1
  s_nop 2
  v_permlane32_swap_b32 v28, v30
  v_permlane32_swap_b32 v29, v31
  v_pk_add_f32 v[28:29], v[28:29], v[30:31]
  v_cvt_pk_bf16_f32 v28, v28, v29
  buffer_store_dword v28, v3, s[4:7], s79 offen
  buffer_store_dword v5, v3, s[4:7], s89 offen
  s_waitcnt vmcnt(0)
CH_M0:
  v_lshrrev_b32 v25, 1, v0
  s_barrier
CH_L0:
  buffer_load_dwordx4 v[32:35], v0, s[4:7], s78 offen offset:0 sc1
  buffer_load_dwordx4 v[36:39], v0, s[4:7], s78 offen offset:1024 sc1
  buffer_load_dwordx2 v[40:41], v25, s[4:7], s78 offen offset:2048 sc1
  s_cmp_gt_u32 s80, s72
  s_cbranch_scc1 CH_W0
  s_waitcnt vmcnt(0)
  s_lshl_b32 s89, s69, 4
L_16:
  buffer_load_dwordx4 v[8:11], off, s[4:7], s89 sc1
L_16x:
  s_waitcnt vmcnt(0)
  v_min_u32 v8, v8, v9
  v_min3_u32 v8, v8, v10, v11
  s_nop 0
  v_readfirstlane_b32 s80, v8
  s_lshl_b32 s80, s80, 2
  s_cmp_gt_u32 s80, s72
  s_cbranch_scc1 D_17
  s_sub_u32 s68, s68, 1
  s_cbranch_scc0 L_16
  s_mov_b32 s68, 0
D_17:
  s_branch CH_W0
CH_F0:
  s_sub_u32 s68, s68, 1
  s_cbranch_scc0 CH_L0
  s_mov_b32 s68, 0
  s_branch CH_G0
CH_E0:
  buffer_load_dwordx4 v[8:11], v0, s[4:7], s76 offen offset:0 sc1
  buffer_load_dwordx4 v[12:15], v0, s[4:7], s76 offen offset:1024 sc1
  buffer_load_dwordx4 v[16:19], v0, s[4:7], s76 offen offset:2048 sc1
  buffer_load_dwordx4 v[20:23], v0, s[4:7], s76 offen offset:3072 sc1
  v_mov_b32 v29, 0x3f80
  v_mov_b32 v30, 1.0
  v_cndmask_b32 v29, v29, v30, s[52:53]
  v_and_b32 v3, 0x30, v0
  v_and_or_b32 v3, v7, 64, v3
  v_lshrrev_b32 v4, 13, v7
  v_lshl_or_b32 v3, v4, 3, v3
  v_bfe_u32 v4, v7, 5, 1
  v_lshl_or_b32 v3, v4, 2, v3
  v_cndmask_b32 v24, 0, v29, s[54:55]
  v_cndmask_b32 v25, 0, v29, s[56:57]
  v_cndmask_b32 v26, 0, v29, s[58:59]
  v_cndmask_b32 v27, 0, v29, s[60:61]
  s_add_u32 s89, s72, 2
  s_and_b32 s89, s89, 3
  s_mul_i32 s89, s89, 10240
  s_add_u32 s89, s89, s77
  s_sub_u32 s68, s68, 1
  s_cselect_b32 s68, 0, s68
  s_cselect_b32 s82, 1, 0
  s_waitcnt vmcnt(3)
  v_mfma_f32_16x16x32_bf16 v[28:31], v[8:11], v[24:27], 0
  v_bitop3_b32 v4, v8, v10, s72 bitop3:0xbd
  s_waitcnt vmcnt(2)
  v_mfma_f32_16x16x32_bf16 v[28:31], v[12:15], v[24:27], v[28:31]
  v_bitop3_b32 v5, v12, v14, s72 bitop3:0xbd
  v_or_b32 v4, v4, v5
  s_waitcnt vmcnt(1)
  v_mfma_f32_16x16x32_bf16 v[28:31], v[16:19], v[24:27], v[28:31]
  v_bitop3_b32 v5, v16, v18, s72 bitop3:0xbd
  v_or_b32 v4, v4, v5
  s_waitcnt vmcnt(0)
  v_mfma_f32_16x16x32_bf16 v[28:31], v[20:23], v[24:27], v[28:31]
  v_bitop3_b32 v5, v20, v22, s72 bitop3:0xbd
  v_bitop3_b32 v4, v4, v5, 1 bitop3:0xa8
  v_cmp_lt_u32 vcc, s82, v4
  s_cbranch_vccnz CH_P0
  s_branch CH_PD0
CH_N0:
  s_branch CH_M0
CH_W1:
  v_mov_b64 v[8:9], 0
  v_mov_b64 v[10:11], 0
  v_mov_b64 v[12:13], 0
  v_mov_b64 v[14:15], 0
  v_mov_b64 v[16:17], 0
  v_mov_b64 v[18:19], 0
  v_mov_b64 v[20:21], 0
  v_mov_b64 v[22:23], 0
  v_add_u32 v26, s84, v0
  v_add_u32 v27, s84, v25
  s_waitcnt vmcnt(2)
  ds_write_b128 v26, v[32:35]
  v_max3_u32 v24, v32, v33, v34
  s_waitcnt vmcnt(1)
  ds_write_b128 v26, v[36:39] offset:1024
  v_max3_u32 v24, v24, v35, v36
  v_max3_u32 v24, v24, v37, v38
  v_max_u32 v24, v24, v39
  s_waitcnt vmcnt(0)
  ds_write_b64 v27, v[40:41] offset:2048
  v_max3_u32 v24, v24, v40, v41
  v_cmp_eq_u32 vcc, -1, v24
  s_cbranch_vccnz CH_F1
CH_G1:
  buffer_load_dwordx4 v[40:43], v0, s[4:7], s70 offen offset:0 sc1
  buffer_load_dwordx4 v[44:47], v0, s[4:7], s70 offen offset:1024 sc1
  s_waitcnt lgkmcnt(0)
  s_barrier
  ds_read_b128 v[24:27], v0 offset:0
  ds_read_b128 v[4:7], v0 offset:1024
  ds_read_b128 v[28:31], v0 offset:2048
  buffer_load_dwordx4 v[32:35], v0, s[4:7], s73 offen offset:0 sc1 nt
  buffer_load_dwordx4 v[36:39], v0, s[4:7], s73 offen offset:1024 sc1 nt
  s_waitcnt lgkmcnt(2)
  v_smfmac_f32_16x16x64_bf16 v[8:11], v[24:27], v[48:55], v2
  ds_read_b128 v[48:51], v1 offset:0
  ds_read_b128 v[52:55], v1 offset:1024
  v_smfmac_f32_16x16x64_bf16 v[12:15], v[24:27], v[56:63], v2
  ds_read_b128 v[56:59], v1 offset:2048
  ds_read_b128 v[60:63], v1 offset:3072
  v_smfmac_f32_16x16x64_bf16 v[16:19], v[24:27], a[0:7], v2
  v_smfmac_f32_16x16x64_bf16 v[20:23], v[24:27], a[8:15], v2
  ds_read_b128 v[24:27], v0 offset:3072
  s_waitcnt lgkmcnt(6)
  v_smfmac_f32_16x16x64_bf16 v[8:11], v[4:7], a[32:39], v2
  v_smfmac_f32_16x16x64_bf16 v[12:15], v[4:7], a[40:47], v2
  s_waitcnt lgkmcnt(3)
  v_smfmac_f32_16x16x64_bf16 v[16:19], v[4:7], v[48:55], v2
  ds_read_b128 v[48:51], v1 offset:4096
  ds_read_b128 v[52:55], v1 offset:5120
  s_waitcnt lgkmcnt(3)
  v_smfmac_f32_16x16x64_bf16 v[20:23], v[4:7], v[56:63], v2
  ds_read_b128 v[4:7], v0 offset:4096
  ds_read_b128 v[56:59], v1 offset:6144
  ds_read_b128 v[60:63], v1 offset:7168
  v_smfmac_f32_16x16x64_bf16 v[8:11], v[28:31], a[64:71], v2
  v_smfmac_f32_16x16x64_bf16 v[12:15], v[28:31], a[72:79], v2
  v_smfmac_f32_16x16x64_bf16 v[16:19], v[28:31], a[80:87], v2
  v_smfmac_f32_16x16x64_bf16 v[20:23], v[28:31], a[88:95], v2
  ds_read_b128 v[28:31], v0 offset:5120
  s_waitcnt lgkmcnt(6)
  s_waitcnt lgkmcnt(4)
  v_smfmac_f32_16x16x64_bf16 v[8:11], v[24:27], v[48:55], v2
  ds_read_b128 v[48:51], v1 offset:8192
  ds_read_b128 v[52:55], v1 offset:9216
  s_waitcnt lgkmcnt(3)
  v_smfmac_f32_16x16x64_bf16 v[12:15], v[24:27], v[56:63], v2
  ds_read_b128 v[56:59], v1 offset:10240
  ds_read_b128 v[60:63], v1 offset:11264
  s_waitcnt vmcnt(2)
  v_smfmac_f32_16x16x64_bf16 v[16:19], v[24:27], v[40:47], v2
  buffer_load_dwordx4 v[40:43], v0, s[4:7], s70 offen offset:2048 sc1
  v_smfmac_f32_16x16x64_bf16 v[20:23], v[24:27], v[248:255], v2
  ds_read_b128 v[24:27], v0 offset:6144
  v_smfmac_f32_16x16x64_bf16 v[8:11], v[4:7], a[144:151], v2
  v_mov_b32 v3, s72
  v_smfmac_f32_16x16x64_bf16 v[12:15], v[4:7], a[152:159], v2
  s_waitcnt lgkmcnt(3)
  v_smfmac_f32_16x16x64_bf16 v[16:19], v[4:7], v[48:55], v2
  ds_read_b128 v[48:51], v1 offset:12288
  ds_read_b128 v[52:55], v1 offset:13312
  buffer_load_dwordx4 v[44:47], v0, s[4:7], s70 offen offset:3072 sc1
  s_waitcnt lgkmcnt(3)
  v_smfmac_f32_16x16x64_bf16 v[20:23], v[4:7], v[56:63], v2
  ds_read_b128 v[4:7], v0 offset:7168
  ds_read_b128 v[56:59], v1 offset:14336
  ds_read_b128 v[60:63], v1 offset:15360
  v_smfmac_f32_16x16x64_bf16 v[8:11], v[28:31], a[192:199], v2
  v_smfmac_f32_16x16x64_bf16 v[12:15], v[28:31], a[200:207], v2
  v_smfmac_f32_16x16x64_bf16 v[16:19], v[28:31], a[208:215], v2
  v_smfmac_f32_16x16x64_bf16 v[20:23], v[28:31], a[216:223], v2
  ds_read_b128 v[28:31], v0 offset:8192
  s_waitcnt lgkmcnt(6)
  s_waitcnt lgkmcnt(4)
  v_smfmac_f32_16x16x64_bf16 v[8:11], v[24:27], v[48:55], v2
  ds_read_b128 v[48:51], v1 offset:16384
  ds_read_b128 v[52:55], v1 offset:17408
  s_waitcnt lgkmcnt(3)
  v_smfmac_f32_16x16x64_bf16 v[12:15], v[24:27], v[56:63], v2
  ds_read_b128 v[56:59], v1 offset:18432
  ds_read_b128 v[60:63], v1 offset:19456
  v_smfmac_f32_16x16x64_bf16 v[16:19], v[24:27], v[64:71], v2
  s_mov_b64 exec, s[64:65]
  buffer_store_dwordx4 v[0:3], v0, s[4:7], s85 offen sc1
  s_mov_b64 exec, -1
  v_smfmac_f32_16x16x64_bf16 v[20:23], v[24:27], v[72:79], v2
  ds_read_b128 v[24:27], v0 offset:9216
  v_smfmac_f32_16x16x64_bf16 v[8:11], v[4:7], v[96:103], v2
  v_smfmac_f32_16x16x64_bf16 v[12:15], v[4:7], v[104:111], v2
  s_waitcnt lgkmcnt(3)
  v_smfmac_f32_16x16x64_bf16 v[16:19], v[4:7], v[48:55], v2
  s_waitcnt lgkmcnt(1)
  v_smfmac_f32_16x16x64_bf16 v[20:23], v[4:7], v[56:63], v2
  ds_read_b128 v[4:7], v0 offset:15360
  ds_read_b128 v[48:51], v0 offset:0
  ds_read_b128 v[52:55], v0 offset:1024
  v_smfmac_f32_16x16x64_bf16 v[8:11], v[28:31], v[144:151], v2
  v_smfmac_f32_16x16x64_bf16 v[12:15], v[28:31], v[152:159], v2
  s_waitcnt lgkmcnt(3)
  v_smfmac_f32_16x16x64_bf16 v[8:11], v[24:27], v[208:215], v2
  v_smfmac_f32_16x16x64_bf16 v[12:15], v[24:27], v[216:223], v2
  v_smfmac_f32_16x16x64_bf16 v[16:19], v[28:31], v[160:167], v2
  v_cvt_pk_bf16_f32 v56, v8, v9
  v_smfmac_f32_16x16x64_bf16 v[20:23], v[28:31], v[168:175], v2
  v_cvt_pk_bf16_f32 v57, v10, v11
  v_cvt_pk_bf16_f32 v58, v12, v13
  buffer_load_dwordx4 v[28:31], v0, s[4:7], s73 offen offset:3072 sc1 nt
  v_smfmac_f32_16x16x64_bf16 v[16:19], v[24:27], v[240:247], v2
  v_cvt_pk_bf16_f32 v59, v14, v15
  s_waitcnt lgkmcnt(2)
  v_mfma_f32_16x16x16_bf16 v[8:11], v[56:57], v[4:5], 0
  v_mfma_f32_16x16x16_bf16 v[12:15], v[58:59], v[4:5], 0
  v_cvt_pk_bf16_f32 v60, v16, v17
  v_cvt_pk_bf16_f32 v61, v18, v19
  s_nop 1
  v_cvt_pk_bf16_f32 v56, v8, v9
  v_mfma_f32_16x16x16_bf16 v[16:19], v[60:61], v[4:5], 0
  v_cvt_pk_bf16_f32 v57, v10, v11
  v_mov_b64 v[8:9], 0
  v_mov_b64 v[10:11], 0
  v_cvt_pk_bf16_f32 v58, v12, v13
  v_cvt_pk_bf16_f32 v59, v14, v15
  v_mov_b64 v[12:13], 0
  v_mov_b64 v[14:15], 0
  s_waitcnt lgkmcnt(1)
  v_smfmac_f32_16x16x64_bf16 v[8:11], v[48:51], a[16:23], v2
  v_cvt_pk_bf16_f32 v60, v16, v17
  v_smfmac_f32_16x16x64_bf16 v[12:15], v[48:51], a[24:31], v2
  v_cvt_pk_bf16_f32 v61, v18, v19
  ds_read_b128 v[48:51], v0 offset:2048
  s_waitcnt lgkmcnt(1)
  v_smfmac_f32_16x16x64_bf16 v[8:11], v[52:55], a[48:55], v2
  v_smfmac_f32_16x16x64_bf16 v[12:15], v[52:55], a[56:63], v2
  ds_read_b128 v[52:55], v0 offset:3072
  s_waitcnt lgkmcnt(1)
  v_smfmac_f32_16x16x64_bf16 v[8:11], v[48:51], a[96:103], v2
  v_smfmac_f32_16x16x64_bf16 v[12:15], v[48:51], a[104:111], v2
  ds_read_b128 v[48:51], v0 offset:4096
  s_waitcnt vmcnt(2)
  v_smfmac_f32_16x16x64_bf16 v[20:23], v[24:27], v[40:47], v2
  buffer_load_dwordx4 v[24:27], v0, s[4:7], s73 offen offset:2048 sc1 nt
  v_mfma_f32_16x16x32_bf16 v[40:43], v[32:35], v[56:59], 0
  ds_read_b128 v[32:35], v0 offset:5120
  v_add_u32 v16, s86, v0
  v_bfe_u32 v17, v0, 1, 8
  v_mfma_f32_16x16x32_bf16 v[44:47], v[36:39], v[56:59], 0
  ds_read_b128 v[36:39], v0 offset:6144
  v_cvt_pk_bf16_f32 v62, v20, v21
  v_cvt_pk_bf16_f32 v63, v22, v23
  v_add_u32 v17, s83, v17
  s_nop 0
  v_mfma_f32_16x16x16_bf16 v[20:23], v[62:63], v[4:5], 0
  s_mov_b64 exec, s[92:93]
  s_nop 0
  v_mov_b64 v[40:41], v[44:45]
  v_mov_b64 v[42:43], v[46:47]
  s_mov_b64 exec, -1
  ds_write_b128 v16, v[40:43] offset:10240
  s_nop 1
  v_cvt_pk_bf16_f32 v62, v20, v21
  v_cvt_pk_bf16_f32 v63, v22, v23
  s_nop 1
  v_mfma_f32_16x16x32_bf16 v[20:23], v[60:63], v[56:59], 0
  s_mov_b64 exec, s[92:93]
  buffer_store_dwordx4 v[60:63], v0, s[4:7], s74 offen sc1
  s_waitcnt lgkmcnt(4)
  v_smfmac_f32_16x16x64_bf16 v[8:11], v[52:55], a[128:135], v2
  s_nop 3
  v_mov_b64 v[20:21], v[22:23]
  s_mov_b64 exec, -1
  ds_write_b64 v17, v[20:21] offset:14336
  v_smfmac_f32_16x16x64_bf16 v[12:15], v[52:55], a[136:143], v2
  ds_read_b128 v[52:55], v0 offset:7168
  v_bfe_u32 v62, v0, 1, 8
  s_waitcnt lgkmcnt(5)
  v_smfmac_f32_16x16x64_bf16 v[8:11], v[48:51], a[160:167], v2
  v_smfmac_f32_16x16x64_bf16 v[12:15], v[48:51], a[168:175], v2
  ds_read_b128 v[48:51], v0 offset:8192
  s_waitcnt lgkmcnt(2)
  s_barrier
  ds_read_b128 v[40:43], v0 offset:10240
  ds_read_b64 v[56:57], v62 offset:14336
  ds_read_b128 v[44:47], v0 offset:11264
  ds_read_b64 v[58:59], v62 offset:14592
  ds_read_b128 v[16:19], v0 offset:12288
  ds_read_b64 v[60:61], v62 offset:14848
  ds_read_b128 v[20:23], v0 offset:13312
  ds_read_b64 v[62:63], v62 offset:15104
  v_smfmac_f32_16x16x64_bf16 v[8:11], v[32:35], a[224:231], v2
  v_smfmac_f32_16x16x64_bf16 v[12:15], v[32:35], a[232:239], v2
  ds_read_b128 v[32:35], v0 offset:9216
  v_smfmac_f32_16x16x64_bf16 v[8:11], v[36:39], v[80:87], v2
  v_smfmac_f32_16x16x64_bf16 v[12:15], v[36:39], v[88:95], v2
  s_waitcnt lgkmcnt(10)
  v_smfmac_f32_16x16x64_bf16 v[8:11], v[52:55], v[112:119], v2
  v_smfmac_f32_16x16x64_bf16 v[12:15], v[52:55], v[120:127], v2
  s_waitcnt lgkmcnt(9)
  v_smfmac_f32_16x16x64_bf16 v[8:11], v[48:51], v[176:183], v2
  v_smfmac_f32_16x16x64_bf16 v[12:15], v[48:51], v[184:191], v2
  s_waitcnt lgkmcnt(5)
  v_pk_add_f32 v[40:41], v[40:41], v[44:45]
  v_pk_add_f32 v[42:43], v[42:43], v[46:47]
  v_pk_add_f32 v[56:57], v[56:57], v[58:59]
  s_waitcnt lgkmcnt(1)
  v_pk_add_f32 v[16:17], v[16:17], v[20:21]
  v_pk_add_f32 v[18:19], v[18:19], v[22:23]
  v_pk_add_f32 v[60:61], v[60:61], v[62:63]
  v_pk_add_f32 v[40:41], v[40:41], v[16:17]
  v_pk_add_f32 v[42:43], v[42:43], v[18:19]
  v_pk_add_f32 v[44:45], v[56:57], v[60:61]
  buffer_load_dwordx4 v[56:59], v0, s[4:7], s71 offen offset:2048 sc1
  v_max3_f32 v22, v40, v41, v42
  v_max3_f32 v22, v22, v43, v44
  v_max_f32 v22, v22, v45
  s_waitcnt lgkmcnt(0)
  v_smfmac_f32_16x16x64_bf16 v[8:11], v[32:35], v[224:231], v2
  v_max_f32_dpp v22, v22, v22 row_ror:8 row_mask:0xf bank_mask:0xf
  v_mov_b32 v23, v22
  v_smfmac_f32_16x16x64_bf16 v[12:15], v[32:35], v[232:239], v2
  s_nop 0
  v_permlane16_swap_b32 v22, v23
  v_max_f32 v22, v22, v23
  v_mov_b32 v23, v22
  buffer_load_dwordx4 v[60:63], v0, s[4:7], s71 offen offset:3072 sc1
  s_nop 0
  v_permlane32_swap_b32 v22, v23
  v_max_f32 v22, v22, v23
  v_mul_f32 v22, s94, v22
  v_fma_f32 v40, v40, s94, -v22
  v_fma_f32 v41, v41, s94, -v22
  v_fma_f32 v42, v42, s94, -v22
  v_fma_f32 v43, v43, s94, -v22
  v_fma_f32 v44, v44, s94, -v22
  v_fma_f32 v45, v45, s94, -v22
  v_exp_f32 v40, v40
  v_exp_f32 v41, v41
  v_exp_f32 v42, v42
  v_exp_f32 v43, v43
  buffer_load_dwordx4 v[48:51], v0, s[4:7], s71 offen offset:0 sc1
  v_exp_f32 v44, v44
  v_exp_f32 v45, v45
  v_cvt_pk_bf16_f32 v16, v40, v41
  v_cvt_pk_bf16_f32 v17, v42, v43
  v_cvt_pk_bf16_f32 v20, v44, v45
  v_mov_b64 v[36:37], s[12:13]
  v_mov_b64 v[38:39], s[12:13]
  v_mov_b32_dpp v18, v16 row_ror:8 row_mask:0xf bank_mask:0xf
  v_mov_b32_dpp v19, v17 row_ror:8 row_mask:0xf bank_mask:0xf
  v_mov_b32_dpp v21, v20 row_ror:8 row_mask:0xf bank_mask:0xf
  buffer_load_dwordx4 v[52:55], v0, s[4:7], s71 offen offset:1024 sc1
  v_mfma_f32_16x16x32_bf16 v[40:43], v[36:39], v[16:19], 0
  v_cvt_pk_bf16_f32 v44, v8, v9
  v_cvt_pk_bf16_f32 v45, v10, v11
  s_waitcnt vmcnt(5)
  v_mfma_f32_16x16x32_bf16 v[8:11], v[24:27], v[16:19], 0
  v_mov_b64 v[34:35], s[14:15]
  v_cvt_pk_bf16_f32 v46, v12, v13
  v_cvt_pk_bf16_f32 v47, v14, v15
  v_mfma_f32_16x16x16_bf16 v[40:43], v[34:35], v[20:21], v[40:43]
  v_lshl_add_u32 v32, s3, 9, v6
  v_mfma_f32_16x16x32_bf16 v[12:15], v[28:31], v[16:19], 0
  buffer_store_dwordx4 v[44:47], v0, s[4:7], s74 offen offset:1024 sc1
  v_mfma_f32_16x16x16_bf16 v[8:11], v[44:45], v[20:21], v[8:11]
  v_rcp_f32 v22, v40
  v_mfma_f32_16x16x16_bf16 v[12:15], v[46:47], v[20:21], v[12:15]
  s_cmp_eq_u32 s72, 63
  s_cbranch_scc1 CH_END
  s_add_u32 s73, s73, 524288
  s_add_u32 s74, s74, 262144
  v_mul_f32 v8, v8, v22
  v_mul_f32 v9, v9, v22
  v_mul_f32 v10, v10, v22
  v_mul_f32 v11, v11, v22
  v_pk_mul_f32 v[12:13], v[12:13], v[22:23] op_sel_hi:[1,0]
  v_pk_mul_f32 v[14:15], v[14:15], v[22:23] op_sel_hi:[1,0]
  v_cvt_pk_bf16_f32 v16, v8, v9
  v_cvt_pk_bf16_f32 v17, v10, v11
  v_cvt_pk_bf16_f32 v18, v12, v13
  v_cvt_pk_bf16_f32 v19, v14, v15
  s_mov_b64 exec, s[90:91]
  ds_write_b128 v32, v[16:19]
  s_mov_b64 exec, -1
  ds_read_b128 v[32:35], v1 offset:20480
  ds_read_b128 v[36:39], v1 offset:21504
  ds_read_b128 v[40:43], v1 offset:22528
  ds_read_b128 v[44:47], v1 offset:23552
  v_mov_b64 v[24:25], 0
  v_mov_b64 v[26:27], 0
  v_mov_b64 v[28:29], 0
  v_mov_b64 v[30:31], 0
  s_waitcnt lgkmcnt(4)
  s_barrier
  ds_read_b128 v[8:11], v6 offset:0
  ds_read_b128 v[12:15], v6 offset:512
  ds_read_b128 v[16:19], v6 offset:1024
  ds_read_b128 v[20:23], v6 offset:1536
  s_waitcnt lgkmcnt(3)
  v_smfmac_f32_16x16x64_bf16 v[24:27], v[8:11], v[32:39], v2
  ds_read_b128 v[32:35], v1 offset:24576
  ds_read_b128 v[36:39], v1 offset:25600
  s_waitcnt lgkmcnt(4)
  v_smfmac_f32_16x16x64_bf16 v[24:27], v[12:15], v[40:47], v2
  ds_read_b128 v[40:43], v1 offset:26624
  ds_read_b128 v[44:47], v1 offset:27648
  s_waitcnt lgkmcnt(5)
  s_waitcnt vmcnt(1)
  v_smfmac_f32_16x16x64_bf16 v[24:27], v[16:19], v[48:55], v2
  buffer_load_dwordx4 v[48:51], v0, s[4:7], s87 offen offset:0 sc1
  s_waitcnt lgkmcnt(4)
  v_smfmac_f32_16x16x64_bf16 v[24:27], v[20:23], v[56:63], v2
  v_smfmac_f32_16x16x64_bf16 v[28:31], v[8:11], a[112:119], v2
  buffer_load_dwordx4 v[52:55], v0, s[4:7], s87 offen offset:1024 sc1
  v_smfmac_f32_16x16x64_bf16 v[28:31], v[12:15], a[120:127], v2
  v_cvt_pk_bf16_f32 v4, v24, v25
  v_mov_b64 v[24:25], 0
  s_waitcnt lgkmcnt(2)
  v_smfmac_f32_16x16x64_bf16 v[28:31], v[16:19], v[32:39], v2
  v_cvt_pk_bf16_f32 v5, v26, v27
  v_mov_b64 v[26:27], 0
  ds_read_b128 v[32:35], v1 offset:28672
  ds_read_b128 v[36:39], v1 offset:29696
  s_waitcnt lgkmcnt(2)
  v_smfmac_f32_16x16x64_bf16 v[28:31], v[20:23], v[40:47], v2
  v_bfi_b32 v4, 1, s72, v4
  ds_read_b128 v[40:43], v1 offset:30720
  ds_read_b128 v[44:47], v1 offset:31744
  buffer_load_dwordx4 v[56:59], v0, s[4:7], s87 offen offset:2048 sc1
  v_smfmac_f32_16x16x64_bf16 v[24:27], v[8:11], a[176:183], v2
  buffer_store_dwordx2 v[4:5], v7, s[4:7], s75 offen sc1
  v_smfmac_f32_16x16x64_bf16 v[24:27], v[12:15], a[184:191], v2
  v_cvt_pk_bf16_f32 v4, v28, v29
  v_mov_b64 v[28:29], 0
  v_smfmac_f32_16x16x64_bf16 v[24:27], v[16:19], a[240:247], v2
  v_cvt_pk_bf16_f32 v5, v30, v31
  v_mov_b64 v[30:31], 0
  v_smfmac_f32_16x16x64_bf16 v[24:27], v[20:23], a[248:255], v2
  v_bfi_b32 v4, 1, s72, v4
  buffer_load_dwordx4 v[60:63], v0, s[4:7], s87 offen offset:3072 sc1
  s_waitcnt lgkmcnt(2)
  v_smfmac_f32_16x16x64_bf16 v[28:31], v[8:11], v[32:39], v2
  buffer_store_dwordx2 v[4:5], v7, s[4:7], s16 offen sc1
  ds_read_b128 v[32:35], v1 offset:32768
  ds_read_b128 v[36:39], v1 offset:33792
  s_waitcnt lgkmcnt(2)
  v_smfmac_f32_16x16x64_bf16 v[28:31], v[12:15], v[40:47], v2
  v_cvt_pk_bf16_f32 v4, v24, v25
  v_mov_b64 v[24:25], 0
  ds_read_b128 v[40:43], v1 offset:34816
  ds_read_b128 v[44:47], v1 offset:35840
  v_smfmac_f32_16x16x64_bf16 v[28:31], v[16:19], v[128:135], v2
  v_cvt_pk_bf16_f32 v5, v26, v27
  v_mov_b64 v[26:27], 0
  v_smfmac_f32_16x16x64_bf16 v[28:31], v[20:23], v[136:143], v2
  v_bfi_b32 v4, 1, s72, v4
  v_smfmac_f32_16x16x64_bf16 v[24:27], v[8:11], v[192:199], v2
  buffer_store_dwordx2 v[4:5], v7, s[4:7], s17 offen sc1
  v_smfmac_f32_16x16x64_bf16 v[24:27], v[12:15], v[200:207], v2
  v_cvt_pk_bf16_f32 v4, v28, v29
  s_waitcnt lgkmcnt(2)
  v_smfmac_f32_16x16x64_bf16 v[24:27], v[16:19], v[32:39], v2
  v_cvt_pk_bf16_f32 v5, v30, v31
  v_bfi_b32 v4, 1, s72, v4
  s_waitcnt lgkmcnt(0)
  v_smfmac_f32_16x16x64_bf16 v[24:27], v[20:23], v[40:47], v2
  buffer_store_dwordx2 v[4:5], v7, s[4:7], s18 offen sc1
  s_add_u32 s89, s72, 1
  s_and_b32 s78, s89, 3
  s_mul_i32 s78, s78, 10240
  s_add_u32 s79, s77, s78
  s_add_u32 s78, s78, s20
  s_cmp_eq_u32 s81, 0
  s_nop 0
  v_cvt_pk_bf16_f32 v24, v24, v25
  v_cvt_pk_bf16_f32 v25, v26, v27
  v_bfi_b32 v24, 1, s72, v24
  buffer_store_dwordx2 v[24:25], v7, s[4:7], s19 offen sc1
  s_mov_b32 s72, s89
  s_cbranch_scc1 CH_N1
  s_cmp_eq_u32 s3, 0
  s_cbranch_scc0 CH_E1
  v_mov_b32 v29, 0x3f80
  v_mov_b32 v30, 1.0
  v_cndmask_b32 v29, v29, v30, s[52:53]
  v_and_b32 v3, 0x30, v0
  v_and_or_b32 v3, v7, 64, v3
  v_lshrrev_b32 v4, 13, v7
  v_lshl_or_b32 v3, v4, 3, v3
  v_bfe_u32 v4, v7, 5, 1
  v_lshl_or_b32 v3, v4, 2, v3
  v_cndmask_b32 v24, 0, v29, s[54:55]
  v_cndmask_b32 v25, 0, v29, s[56:57]
  v_cndmask_b32 v26, 0, v29, s[58:59]
  v_cndmask_b32 v27, 0, v29, s[60:61]
  s_add_u32 s89, s72, 2
  s_and_b32 s89, s89, 3
  s_mul_i32 s89, s89, 10240
  s_add_u32 s89, s89, s77
  s_waitcnt vmcnt(0)
CH_P1:
  buffer_load_dwordx4 v[8:11], v0, s[4:7], s76 offen offset:0 sc1
  buffer_load_dwordx4 v[12:15], v0, s[4:7], s76 offen offset:1024 sc1
  buffer_load_dwordx4 v[16:19], v0, s[4:7], s76 offen offset:2048 sc1
  buffer_load_dwordx4 v[20:23], v0, s[4:7], s76 offen offset:3072 sc1
  s_sub_u32 s68, s68, 1
  s_cselect_b32 s68, 0, s68
  s_cselect_b32 s82, 1, 0
  s_waitcnt vmcnt(3)
  v_mfma_f32_16x16x32_bf16 v[28:31], v[8:11], v[24:27], 0
  v_bitop3_b32 v4, v8, v10, s72 bitop3:0xbd
  s_waitcnt vmcnt(2)
  v_mfma_f32_16x16x32_bf16 v[28:31], v[12:15], v[24:27], v[28:31]
  v_bitop3_b32 v5, v12, v14, s72 bitop3:0xbd
  v_or_b32 v4, v4, v5
  s_waitcnt vmcnt(1)
  v_mfma_f32_16x16x32_bf16 v[28:31], v[16:19], v[24:27], v[28:31]
  v_bitop3_b32 v5, v16, v18, s72 bitop3:0xbd
  v_or_b32 v4, v4, v5
  s_waitcnt vmcnt(0)
  v_mfma_f32_16x16x32_bf16 v[28:31], v[20:23], v[24:27], v[28:31]
  v_bitop3_b32 v5, v20, v22, s72 bitop3:0xbd
  v_bitop3_b32 v4, v4, v5, 1 bitop3:0xa8
  v_cmp_lt_u32 vcc, s82, v4
  s_cbranch_vccnz CH_P1
CH_PD1:
  v_mov_b32 v5, -1
  s_nop 2
  v_permlane32_swap_b32 v28, v30
  v_permlane32_swap_b32 v29, v31
  v_pk_add_f32 v[28:29], v[28:29], v[30:31]
  v_cvt_pk_bf16_f32 v28, v28, v29
  buffer_store_dword v28, v3, s[4:7], s79 offen sc1
  buffer_store_dword v5, v3, s[4:7], s89 offen sc1
  s_waitcnt vmcnt(0)
CH_M1:
  v_lshrrev_b32 v25, 1, v0
  s_barrier
CH_L1:
  buffer_load_dwordx4 v[32:35], v0, s[4:7], s78 offen offset:0 sc1
  buffer_load_dwordx4 v[36:39], v0, s[4:7], s78 offen offset:1024 sc1
  buffer_load_dwordx2 v[40:41], v25, s[4:7], s78 offen offset:2048 sc1
  s_cmp_gt_u32 s80, s72
  s_cbranch_scc1 CH_W1
  s_waitcnt vmcnt(0)
  s_lshl_b32 s89, s69, 4
L_18:
  buffer_load_dwordx4 v[8:11], off, s[4:7], s89 sc1
L_18x:
  s_waitcnt vmcnt(0)
  v_min_u32 v8, v8, v9
  v_min3_u32 v8, v8, v10, v11
  s_nop 0
  v_readfirstlane_b32 s80, v8
  s_lshl_b32 s80, s80, 2
  s_cmp_gt_u32 s80, s72
  s_cbranch_scc1 D_19
  s_sub_u32 s68, s68, 1
  s_cbranch_scc0 L_18
  s_mov_b32 s68, 0
D_19:
  s_branch CH_W1
CH_F1:
  s_sub_u32 s68, s68, 1
  s_cbranch_scc0 CH_L1
  s_mov_b32 s68, 0
  s_branch CH_G1
CH_E1:
  buffer_load_dwordx4 v[8:11], v0, s[4:7], s76 offen offset:0 sc1
  buffer_load_dwordx4 v[12:15], v0, s[4:7], s76 offen offset:1024 sc1
  buffer_load_dwordx4 v[16:19], v0, s[4:7], s76 offen offset:2048 sc1
  buffer_load_dwordx4 v[20:23], v0, s[4:7], s76 offen offset:3072 sc1
  v_mov_b32 v29, 0x3f80
  v_mov_b32 v30, 1.0
  v_cndmask_b32 v29, v29, v30, s[52:53]
  v_and_b32 v3, 0x30, v0
  v_and_or_b32 v3, v7, 64, v3
  v_lshrrev_b32 v4, 13, v7
  v_lshl_or_b32 v3, v4, 3, v3
  v_bfe_u32 v4, v7, 5, 1
  v_lshl_or_b32 v3, v4, 2, v3
  v_cndmask_b32 v24, 0, v29, s[54:55]
  v_cndmask_b32 v25, 0, v29, s[56:57]
  v_cndmask_b32 v26, 0, v29, s[58:59]
  v_cndmask_b32 v27, 0, v29, s[60:61]
  s_add_u32 s89, s72, 2
  s_and_b32 s89, s89, 3
  s_mul_i32 s89, s89, 10240
  s_add_u32 s89, s89, s77
  s_sub_u32 s68, s68, 1
  s_cselect_b32 s68, 0, s68
  s_cselect_b32 s82, 1, 0
  s_waitcnt vmcnt(3)
  v_mfma_f32_16x16x32_bf16 v[28:31], v[8:11], v[24:27], 0
  v_bitop3_b32 v4, v8, v10, s72 bitop3:0xbd
  s_waitcnt vmcnt(2)
  v_mfma_f32_16x16x32_bf16 v[28:31], v[12:15], v[24:27], v[28:31]
  v_bitop3_b32 v5, v12, v14, s72 bitop3:0xbd
  v_or_b32 v4, v4, v5
  s_waitcnt vmcnt(1)
  v_mfma_f32_16x16x32_bf16 v[28:31], v[16:19], v[24:27], v[28:31]
  v_bitop3_b32 v5, v16, v18, s72 bitop3:0xbd
  v_or_b32 v4, v4, v5
  s_waitcnt vmcnt(0)
  v_mfma_f32_16x16x32_bf16 v[28:31], v[20:23], v[24:27], v[28:31]
  v_bitop3_b32 v5, v20, v22, s72 bitop3:0xbd
  v_bitop3_b32 v4, v4, v5, 1 bitop3:0xa8
  v_cmp_lt_u32 vcc, s82, v4
  s_cbranch_vccnz CH_P1
  s_branch CH_PD1
CH_N1:
  s_branch CH_M1
CH_END:
  s_waitcnt vmcnt(0) lgkmcnt(0)
  s_barrier
  v_mov_b32 v8, 64
  buffer_store_dword v8, off, s[4:7], s85 offset:12 sc1
END:
  s_waitcnt vmcnt(0)
  s_endpgm
.section .rodata,"a"
.p2align 6
.amdhsa_kernel gated_mix__grouped_kv_mqa__memory_aug_recurrent_mem_tr__prompt_kernel
  .amdhsa_next_free_vgpr 512
  .amdhsa_next_free_sgpr 102
  .amdhsa_accum_offset 256
  .amdhsa_group_segment_fixed_size 0
  .amdhsa_kernarg_size 128
  .amdhsa_user_sgpr_count 2
  .amdhsa_user_sgpr_kernarg_segment_ptr 1
  .amdhsa_system_sgpr_workgroup_id_x 1
.end_amdhsa_kernel
```
